```python
import torch

def _softmax(x, axis=-1):
    return torch.softmax(x, dim=axis)
def _gelu(x):
    return torch.nn.functional.gelu(x, approximate="tanh")
def _silu(x):
    return torch.nn.functional.silu(x)
def _sigmoid(x):
    return torch.sigmoid(x)
def _layernorm(x, axis=-1, eps=1e-5):
    m = x.mean(dim=axis, keepdim=True)
    v = x.var(dim=axis, keepdim=True, unbiased=False)
    return (x - m) / torch.sqrt(v + eps)
def _scatter_add(tgt, idx, src, axis=0):
    return tgt.clone().index_add_(axis, idx, src)
def _segment_sum(src, seg, n):
    out = torch.zeros((n,) + src.shape[1:], dtype=src.dtype)
    return out.index_add_(0, seg, src)
def _pad(x, pw):
    flat = tuple(v for pair in reversed(pw) for v in pair)
    return torch.nn.functional.pad(x, flat)

kernel_name = 'sequential_preLN__compressed_kv_cla__dense_activation_silu__decode'

def setup_inputs():

    _w = (lambda a: (lambda t: t.to(torch.bfloat16) if t.is_floating_point() else t)(torch.as_tensor(a)))
    def _A_setup():
        B, H, Sq, Sk, D, M = 1, 32, 1, 8192, 128, 576
        Dc = 4 * D
        return {
            "x": _w((lambda *s: torch.randn(*s, dtype=torch.bfloat16) * 0.05)(B, Sq, M)),
            "c_kv": _w((lambda *s: torch.randn(*s, dtype=torch.bfloat16) * 0.8)(B, Sk, Dc)),
            "w_q": _w((lambda *s: torch.randn(*s, dtype=torch.bfloat16) * 3.2)(M, H, D) * (M ** -0.5)),
            "w_uk": _w((lambda *s: torch.randn(*s, dtype=torch.bfloat16) * 3.2)(Dc, H, D) * (Dc ** -0.5)),
            "w_uv": _w((lambda *s: torch.randn(*s, dtype=torch.bfloat16) * 0.8)(Dc, H, D) * (Dc ** -0.5)),
            "w_o": _w((lambda *s: torch.randn(*s, dtype=torch.bfloat16) * 0.8)(H, D, M) * ((H * D) ** -0.5)),
        }
    _A_in = _A_setup()

    def _B_setup():
        B, S, D, F = 1, 1, 576, 4608
        return {
            "x": _w((lambda *s: torch.randn(*s, dtype=torch.bfloat16) * 0.05)(B, S, D)),
            "w1": _w((lambda *s: torch.randn(*s, dtype=torch.bfloat16) * 3.2)(D, F) * (D ** -0.5)),
            "w2": _w((lambda *s: torch.randn(*s, dtype=torch.bfloat16) * 0.2)(F, D) * (F ** -0.5)),
        }
    _B_in = _B_setup()

    return {
        "A_x": _A_in["x"],
        "A_c_kv": _A_in["c_kv"],
        "A_w_q": _A_in["w_q"],
        "A_w_uk": _A_in["w_uk"],
        "A_w_uv": _A_in["w_uv"],
        "A_w_o": _A_in["w_o"],
        "B_x": _B_in["x"],
        "B_w1": _B_in["w1"],
        "B_w2": _B_in["w2"],
    }

def reference(A_x, A_c_kv, A_w_q, A_w_uk, A_w_uv, A_w_o, B_x, B_w1, B_w2):
    def _A_ref(x, c_kv, w_q, w_uk, w_uv, w_o):
        B, Sq, M = x.shape[0], x.shape[1], x.shape[2]
        Sk = c_kv.shape[1]
        H, D = w_q.shape[1], w_q.shape[2]
        q = torch.einsum("bqm,mhd->bhqd", x, w_q)
        k = torch.einsum("bkc,chd->bhkd", c_kv, w_uk)
        v = torch.einsum("bkc,chd->bhkd", c_kv, w_uv)
        scores = torch.einsum("bhqd,bhkd->bhqk", q, k) * (D ** -0.5)
        off = Sk - Sq
        qi = torch.arange(Sq)[:, None]
        kj = torch.arange(Sk)[None, :]
        cmask = kj <= (qi + off)
        scores = torch.where(cmask[None, None], scores, -1e9)
        p = _softmax(scores, axis=-1)
        ctx = torch.einsum("bhqk,bhkd->bhqd", p, v)
        return torch.einsum("bhqd,hdm->bqm", ctx, w_o)

    def _B_ref(x, w1, w2):
        h = torch.einsum("bsd,df->bsf", x, w1)
        h = _silu(h)
        out = torch.einsum("bsf,fd->bsd", h, w2)
        return out

    x = A_x
    h = x + _A_ref(_layernorm(x, axis=-1), A_c_kv, A_w_q, A_w_uk, A_w_uv, A_w_o)
    h2 = h + _B_ref(_layernorm(h, axis=-1), B_w1, B_w2)
    return h2
```

```asm
; @launch grid=(256,1,1) block=(512,1,1) lds=157696
.amdgcn_target "amdgcn-amd-amdhsa--gfx950"
.text
.globl sequential_preLN__compressed_kv_cla__dense_activation_silu__decode_kernel
.p2align 8
.type sequential_preLN__compressed_kv_cla__dense_activation_silu__decode_kernel,@function
sequential_preLN__compressed_kv_cla__dense_activation_silu__decode_kernel:
    s_cmp_ge_u32 s2, 256
    s_cbranch_scc1 L_exit
    s_load_dwordx2 s[4:5], s[0:1], 0
    s_load_dwordx2 s[12:13], s[0:1], 16
    s_load_dwordx2 s[8:9], s[0:1], 8
    s_load_dwordx2 s[16:17], s[0:1], 24
    s_load_dwordx2 s[40:41], s[0:1], 88
    s_load_dwordx2 s[20:21], s[0:1], 32
    s_load_dwordx2 s[24:25], s[0:1], 40
    v_lshrrev_b32 v1, 6, v0
    v_and_b32 v0, 63, v0
    v_readfirstlane_b32 s45, v1
    s_lshr_b32 s47, s2, 3
    s_lshl_b32 s50, s47, 3
    s_add_u32 s50, s50, s45
    s_cmp_lg_u32 s50, 128
    s_cbranch_scc1 L_nopf_1
    s_getpc_b64 s[50:51]
L_pc:
    s_sub_u32 s50, s50, L_pc-sequential_preLN__compressed_kv_cla__dense_activation_silu__decode_kernel
    s_subb_u32 s51, s51, 0
    v_lshlrev_b32 v4, 7, v0
    v_min_u32 v5, L_codeend-sequential_preLN__compressed_kv_cla__dense_activation_silu__decode_kernel-4, v4
    global_load_dword v126, v5, s[50:51]
    v_add_u32 v4, 8192, v4
    v_min_u32 v5, L_codeend-sequential_preLN__compressed_kv_cla__dense_activation_silu__decode_kernel-4, v4
    global_load_dword v127, v5, s[50:51]
L_nopf_1:
    v_and_b32 v1, 15, v0
    v_lshrrev_b32 v2, 4, v0
    s_mov_b32 s6, 1152
    s_mov_b32 s7, 0x20000
    s_mov_b32 s10, 8388608
    s_mov_b32 s11, s7
    s_mov_b32 s14, 4718592
    s_mov_b32 s15, s7
    s_mov_b32 s18, 4194304
    s_mov_b32 s19, s7
    s_mov_b32 s22, 4194304
    s_mov_b32 s23, s7
    s_mov_b32 s26, 4718592
    s_mov_b32 s27, s7
    s_mov_b32 s30, 5308416
    s_mov_b32 s31, s7
    s_mov_b32 s34, 5308416
    s_mov_b32 s35, s7
    s_mov_b32 s38, 1152
    s_mov_b32 s39, s7
    s_mov_b32 s42, 3407872
    s_mov_b32 s43, s7
    s_and_b32 s46, s2, 7
    s_cmp_ge_u32 s47, 16
    s_cbranch_scc1 L_X
    s_lshr_b32 s48, s47, 1
    s_and_b32 s48, s48, 6
    s_lshr_b32 s48, 0x78, s48
    s_and_b32 s48, s48, 3
    s_lshl_b32 s50, s46, 2
    s_add_u32 s48, s48, s50
    s_and_b32 s49, s47, 3
    s_cmp_lg_u32 s45, 0
    s_cbranch_scc1 L_Y_not0
    v_lshlrev_b32 v5, 4, v0
    v_lshlrev_b32 v6, 2, v0
    s_mul_i32 s50, s49, 288
    v_mul_u32_u24 v4, 72, v2
    v_mul_u32_u24 v7, 294912, v2
    v_lshl_add_u32 v7, v1, 4, v7
    s_mul_i32 s51, s49, 1179648
    s_lshl_b32 s52, s48, 8
    s_add_u32 s51, s51, s52
    s_lshl_b32 s54, s46, 4
    s_add_u32 s54, s54, s47
    s_lshl_b32 s54, s54, 10
    s_add_u32 s54, s54, 401408
    s_mul_i32 s55, s46, 9
    s_add_u32 s55, s55, s47
    s_lshl_b32 s55, s55, 7
    s_add_u32 s55, s55, 200704
    s_cmp_lt_u32 s47, 9
    s_cselect_b32 s59, 8, 0
    v_mov_b32 v13, 2146435072
    v_cmp_gt_u32 vcc, s59, v0
    v_mov_b32 v64, -1
    v_mov_b32 v65, -1
    v_mov_b32 v66, -1
    v_mov_b32 v67, -1
    v_cndmask_b32 v13, v13, v5, vcc
    s_lshl_b32 s52, s48, 12
    s_lshl_b32 s53, s49, 10
    s_add_u32 s52, s52, s53
    s_add_u32 s53, s52, 532480
    s_add_u32 s52, s52, 4096
    s_waitcnt lgkmcnt(0)
    buffer_load_dwordx4 v[8:11], v5, s[4:7], 0 offen
    buffer_load_dword v12, v6, s[4:7], 0 offen offset:1024
    buffer_load_dwordx4 v[16:19], v4, s[4:7], s50 offen offset:0
    buffer_load_dwordx4 v[20:23], v4, s[4:7], s50 offen offset:16
    buffer_load_dwordx4 v[24:27], v4, s[4:7], s50 offen offset:32
    buffer_load_dwordx4 v[28:31], v4, s[4:7], s50 offen offset:48
    buffer_load_dwordx2 v[32:33], v4, s[4:7], s50 offen offset:64
    buffer_load_dwordx4 v[112:115], v7, s[12:15], s51 offen nt
    s_addk_i32 s51, 8192
    buffer_load_dwordx4 v[116:119], v7, s[12:15], s51 offen nt
    s_addk_i32 s51, 8192
    buffer_load_dwordx4 v[120:123], v7, s[12:15], s51 offen nt
    s_addk_i32 s51, 8192
    buffer_load_dwordx4 v[124:127], v7, s[12:15], s51 offen nt
    s_addk_i32 s51, 8192
    buffer_load_dwordx4 v[128:131], v7, s[12:15], s51 offen nt
    s_addk_i32 s51, 8192
    buffer_load_dwordx4 v[132:135], v7, s[12:15], s51 offen nt
    s_addk_i32 s51, 8192
    buffer_load_dwordx4 v[136:139], v7, s[12:15], s51 offen nt
    s_addk_i32 s51, 8192
    buffer_load_dwordx4 v[140:143], v7, s[12:15], s51 offen nt
    s_addk_i32 s51, 8192
    buffer_load_dwordx4 v[144:147], v7, s[12:15], s51 offen nt
    s_addk_i32 s51, 8192
    buffer_load_dwordx4 v[148:151], v7, s[12:15], s51 offen nt
    s_addk_i32 s51, 8192
    buffer_load_dwordx4 v[152:155], v7, s[12:15], s51 offen nt
    s_addk_i32 s51, 8192
    buffer_load_dwordx4 v[156:159], v7, s[12:15], s51 offen nt
    s_addk_i32 s51, 8192
    buffer_load_dwordx4 v[160:163], v7, s[12:15], s51 offen nt
    s_addk_i32 s51, 8192
    buffer_load_dwordx4 v[164:167], v7, s[12:15], s51 offen nt
    s_addk_i32 s51, 8192
    buffer_load_dwordx4 v[168:171], v7, s[12:15], s51 offen nt
    s_addk_i32 s51, 8192
    buffer_load_dwordx4 v[172:175], v7, s[12:15], s51 offen nt
    s_addk_i32 s51, 8192
    buffer_load_dwordx4 v[176:179], v7, s[12:15], s51 offen nt
    s_addk_i32 s51, 8192
    buffer_load_dwordx4 v[180:183], v7, s[12:15], s51 offen nt
    s_addk_i32 s51, 8192
    buffer_load_dwordx4 v[184:187], v7, s[12:15], s51 offen nt
    s_addk_i32 s51, 8192
    buffer_load_dwordx4 v[188:191], v7, s[12:15], s51 offen nt
    s_addk_i32 s51, 8192
    buffer_load_dwordx4 v[192:195], v7, s[12:15], s51 offen nt
    s_addk_i32 s51, 8192
    buffer_load_dwordx4 v[196:199], v7, s[12:15], s51 offen nt
    s_addk_i32 s51, 8192
    buffer_load_dwordx4 v[200:203], v7, s[12:15], s51 offen nt
    s_addk_i32 s51, 8192
    buffer_load_dwordx4 v[204:207], v7, s[12:15], s51 offen nt
    s_addk_i32 s51, 8192
    buffer_load_dwordx4 v[208:211], v7, s[12:15], s51 offen nt
    s_addk_i32 s51, 8192
    buffer_load_dwordx4 v[212:215], v7, s[12:15], s51 offen nt
    s_addk_i32 s51, 8192
    buffer_load_dwordx4 v[216:219], v7, s[12:15], s51 offen nt
    s_addk_i32 s51, 8192
    buffer_load_dwordx4 v[220:223], v7, s[12:15], s51 offen nt
    s_addk_i32 s51, 8192
    buffer_load_dwordx4 v[224:227], v7, s[12:15], s51 offen nt
    s_addk_i32 s51, 8192
    buffer_load_dwordx4 v[228:231], v7, s[12:15], s51 offen nt
    s_addk_i32 s51, 8192
    buffer_load_dwordx4 v[232:235], v7, s[12:15], s51 offen nt
    s_addk_i32 s51, 8192
    buffer_load_dwordx4 v[236:239], v7, s[12:15], s51 offen nt
    s_addk_i32 s51, 8192
    buffer_load_dwordx4 v[240:243], v7, s[12:15], s51 offen nt
    s_addk_i32 s51, 8192
    buffer_load_dwordx4 v[244:247], v7, s[12:15], s51 offen nt
    s_addk_i32 s51, 8192
    buffer_load_dwordx4 v[248:251], v7, s[12:15], s51 offen nt
    s_addk_i32 s51, 8192
    buffer_load_dwordx4 v[252:255], v7, s[12:15], s51 offen nt
    buffer_store_dwordx4 v[64:67], v5, s[40:43], s53 offen
    buffer_store_dwordx4 v[64:67], v5, s[40:43], s54 offen sc1
    buffer_store_dwordx4 v[64:67], v13, s[40:43], s55 offen sc1
    s_barrier
    s_load_dwordx2 s[28:29], s[0:1], 56
    s_load_dwordx2 s[32:33], s[0:1], 64
    s_load_dwordx2 s[36:37], s[0:1], 72
    s_load_dword s44, s[40:41], 0
    v_and_b32 v34, 2, v1
    v_cmp_ne_u32 vcc, 0, v34
    v_mov_b32 v35, 0x0504
    v_mov_b32 v36, 0x0706
    v_mov_b32 v37, 0x0100
    v_cndmask_b32 v35, v35, v37, vcc
    v_cndmask_b32 v36, v36, v37, vcc
    v_and_b32 v34, 1, v1
    v_lshlrev_b32 v34, 4, v34
    v_xor_b32 v35, 0x0c0c, v35
    v_xor_b32 v36, 0x0c0c, v36
    v_lshlrev_b32 v35, v34, v35
    v_lshlrev_b32 v36, v34, v36
    v_xor_b32 v35, 0x0c0c0c0c, v35
    v_xor_b32 v36, 0x0c0c0c0c, v36
    v_mov_b32 v37, 0x0c0c0c0c
    v_lshrrev_b32 v34, 2, v1
    v_cmp_eq_u32 vcc, 0, v34
    s_nop 1
    v_cndmask_b32 v40, v37, v35, vcc
    v_cndmask_b32 v44, v37, v36, vcc
    v_cmp_eq_u32 vcc, 1, v34
    s_nop 1
    v_cndmask_b32 v41, v37, v35, vcc
    v_cndmask_b32 v45, v37, v36, vcc
    v_cmp_eq_u32 vcc, 2, v34
    s_nop 1
    v_cndmask_b32 v42, v37, v35, vcc
    v_cndmask_b32 v46, v37, v36, vcc
    v_cmp_eq_u32 vcc, 3, v34
    s_nop 1
    v_cndmask_b32 v43, v37, v35, vcc
    v_cndmask_b32 v47, v37, v36, vcc
    v_mov_b32 v38, 0x3f803f80
    v_mov_b32 v34, 0
    v_mov_b32 v35, 0
    v_and_b32 v39, 4, v1
    v_lshlrev_b32 v39, 1, v39
    v_xor_b32 v39, v39, v1
    v_and_b32 v36, 12, v39
    v_add_u32 v36, v36, v2
    v_and_b32 v39, 3, v1
    v_lshl_add_u32 v39, v36, 2, v39
    v_lshlrev_b32 v39, 4, v39
    s_waitcnt vmcnt(44)
    v_dot2_f32_bf16 v34, v8, v38, v34
    v_dot2_f32_bf16 v35, v8, v8, v35
    v_dot2_f32_bf16 v34, v9, v38, v34
    v_dot2_f32_bf16 v35, v9, v9, v35
    v_dot2_f32_bf16 v34, v10, v38, v34
    v_dot2_f32_bf16 v35, v10, v10, v35
    v_dot2_f32_bf16 v34, v11, v38, v34
    v_dot2_f32_bf16 v35, v11, v11, v35
    v_dot2_f32_bf16 v34, v12, v38, v34
    v_dot2_f32_bf16 v35, v12, v12, v35
    s_nop 2
    v_add_f32_dpp v34, v34, v34 row_ror:1 row_mask:0xf bank_mask:0xf
    v_add_f32_dpp v35, v35, v35 row_ror:1 row_mask:0xf bank_mask:0xf
    s_nop 0
    v_add_f32_dpp v34, v34, v34 row_ror:2 row_mask:0xf bank_mask:0xf
    v_add_f32_dpp v35, v35, v35 row_ror:2 row_mask:0xf bank_mask:0xf
    s_nop 0
    v_add_f32_dpp v34, v34, v34 row_ror:4 row_mask:0xf bank_mask:0xf
    v_add_f32_dpp v35, v35, v35 row_ror:4 row_mask:0xf bank_mask:0xf
    s_nop 0
    v_add_f32_dpp v34, v34, v34 row_ror:8 row_mask:0xf bank_mask:0xf
    v_add_f32_dpp v35, v35, v35 row_ror:8 row_mask:0xf bank_mask:0xf
    s_nop 0
    v_mov_b32 v36, v34
    v_mov_b32 v37, v35
    s_nop 0
    v_permlane16_swap_b32 v34, v36
    v_permlane16_swap_b32 v35, v37
    v_add_f32 v34, v34, v36
    v_add_f32 v35, v35, v37
    v_mov_b32 v36, v34
    v_mov_b32 v37, v35
    s_nop 0
    v_permlane32_swap_b32 v34, v36
    v_permlane32_swap_b32 v35, v37
    v_add_f32 v34, v34, v36
    v_add_f32 v35, v35, v37
    v_mul_f32 v34, 0x3ae38e39, v34
    v_mul_f32 v35, 0x3ae38e39, v35
    v_fma_f32 v35, -v34, v34, v35
    v_add_f32 v35, 0x3727c5ac, v35
    v_rsq_f32 v35, v35
    s_waitcnt vmcnt(39)
    v_mul_f32 v35, 0x3e0293ee, v35
    v_perm_b32 v48, v16, v38, v40
    v_perm_b32 v49, v16, v38, v41
    v_perm_b32 v50, v16, v38, v42
    v_perm_b32 v51, v16, v38, v43
    v_perm_b32 v52, v16, v38, v44
    v_perm_b32 v53, v16, v38, v45
    v_perm_b32 v54, v16, v38, v46
    v_perm_b32 v55, v16, v38, v47
    s_waitcnt vmcnt(38)
    v_mfma_f32_16x16x32_bf16 v[56:59], v[48:51], v[112:115], 0
    v_perm_b32 v48, v17, v38, v40
    v_perm_b32 v49, v17, v38, v41
    v_perm_b32 v50, v17, v38, v42
    v_perm_b32 v51, v17, v38, v43
    s_waitcnt vmcnt(37)
    v_mfma_f32_16x16x32_bf16 v[56:59], v[52:55], v[116:119], v[56:59]
    v_perm_b32 v52, v17, v38, v44
    v_perm_b32 v53, v17, v38, v45
    v_perm_b32 v54, v17, v38, v46
    v_perm_b32 v55, v17, v38, v47
    s_waitcnt vmcnt(36)
    v_mfma_f32_16x16x32_bf16 v[56:59], v[48:51], v[120:123], v[56:59]
    v_perm_b32 v48, v18, v38, v40
    v_perm_b32 v49, v18, v38, v41
    v_perm_b32 v50, v18, v38, v42
    v_perm_b32 v51, v18, v38, v43
    s_waitcnt vmcnt(35)
    v_mfma_f32_16x16x32_bf16 v[56:59], v[52:55], v[124:127], v[56:59]
    v_perm_b32 v52, v18, v38, v44
    v_perm_b32 v53, v18, v38, v45
    v_perm_b32 v54, v18, v38, v46
    v_perm_b32 v55, v18, v38, v47
    s_waitcnt vmcnt(34)
    v_mfma_f32_16x16x32_bf16 v[56:59], v[48:51], v[128:131], v[56:59]
    v_perm_b32 v48, v19, v38, v40
    v_perm_b32 v49, v19, v38, v41
    v_perm_b32 v50, v19, v38, v42
    v_perm_b32 v51, v19, v38, v43
    s_waitcnt vmcnt(33)
    v_mfma_f32_16x16x32_bf16 v[56:59], v[52:55], v[132:135], v[56:59]
    v_perm_b32 v52, v19, v38, v44
    v_perm_b32 v53, v19, v38, v45
    v_perm_b32 v54, v19, v38, v46
    v_perm_b32 v55, v19, v38, v47
    s_waitcnt vmcnt(32)
    v_mfma_f32_16x16x32_bf16 v[56:59], v[48:51], v[136:139], v[56:59]
    v_perm_b32 v48, v20, v38, v40
    v_perm_b32 v49, v20, v38, v41
    v_perm_b32 v50, v20, v38, v42
    v_perm_b32 v51, v20, v38, v43
    s_waitcnt vmcnt(31)
    v_mfma_f32_16x16x32_bf16 v[56:59], v[52:55], v[140:143], v[56:59]
    v_perm_b32 v52, v20, v38, v44
    v_perm_b32 v53, v20, v38, v45
    v_perm_b32 v54, v20, v38, v46
    v_perm_b32 v55, v20, v38, v47
    s_waitcnt vmcnt(30)
    v_mfma_f32_16x16x32_bf16 v[56:59], v[48:51], v[144:147], v[56:59]
    v_perm_b32 v48, v21, v38, v40
    v_perm_b32 v49, v21, v38, v41
    v_perm_b32 v50, v21, v38, v42
    v_perm_b32 v51, v21, v38, v43
    s_waitcnt vmcnt(29)
    v_mfma_f32_16x16x32_bf16 v[56:59], v[52:55], v[148:151], v[56:59]
    v_perm_b32 v52, v21, v38, v44
    v_perm_b32 v53, v21, v38, v45
    v_perm_b32 v54, v21, v38, v46
    v_perm_b32 v55, v21, v38, v47
    s_waitcnt vmcnt(28)
    v_mfma_f32_16x16x32_bf16 v[56:59], v[48:51], v[152:155], v[56:59]
    v_perm_b32 v48, v22, v38, v40
    v_perm_b32 v49, v22, v38, v41
    v_perm_b32 v50, v22, v38, v42
    v_perm_b32 v51, v22, v38, v43
    s_waitcnt vmcnt(27)
    v_mfma_f32_16x16x32_bf16 v[56:59], v[52:55], v[156:159], v[56:59]
    v_perm_b32 v52, v22, v38, v44
    v_perm_b32 v53, v22, v38, v45
    v_perm_b32 v54, v22, v38, v46
    v_perm_b32 v55, v22, v38, v47
    s_waitcnt vmcnt(26)
    v_mfma_f32_16x16x32_bf16 v[56:59], v[48:51], v[160:163], v[56:59]
    v_perm_b32 v48, v23, v38, v40
    v_perm_b32 v49, v23, v38, v41
    v_perm_b32 v50, v23, v38, v42
    v_perm_b32 v51, v23, v38, v43
    s_waitcnt vmcnt(25)
    v_mfma_f32_16x16x32_bf16 v[56:59], v[52:55], v[164:167], v[56:59]
    v_perm_b32 v52, v23, v38, v44
    v_perm_b32 v53, v23, v38, v45
    v_perm_b32 v54, v23, v38, v46
    v_perm_b32 v55, v23, v38, v47
    s_waitcnt vmcnt(24)
    v_mfma_f32_16x16x32_bf16 v[56:59], v[48:51], v[168:171], v[56:59]
    v_perm_b32 v48, v24, v38, v40
    v_perm_b32 v49, v24, v38, v41
    v_perm_b32 v50, v24, v38, v42
    v_perm_b32 v51, v24, v38, v43
    s_waitcnt vmcnt(23)
    v_mfma_f32_16x16x32_bf16 v[56:59], v[52:55], v[172:175], v[56:59]
    v_perm_b32 v52, v24, v38, v44
    v_perm_b32 v53, v24, v38, v45
    v_perm_b32 v54, v24, v38, v46
    v_perm_b32 v55, v24, v38, v47
    s_waitcnt vmcnt(22)
    v_mfma_f32_16x16x32_bf16 v[56:59], v[48:51], v[176:179], v[56:59]
    v_perm_b32 v48, v25, v38, v40
    v_perm_b32 v49, v25, v38, v41
    v_perm_b32 v50, v25, v38, v42
    v_perm_b32 v51, v25, v38, v43
    s_waitcnt vmcnt(21)
    v_mfma_f32_16x16x32_bf16 v[56:59], v[52:55], v[180:183], v[56:59]
    v_perm_b32 v52, v25, v38, v44
    v_perm_b32 v53, v25, v38, v45
    v_perm_b32 v54, v25, v38, v46
    v_perm_b32 v55, v25, v38, v47
    s_waitcnt vmcnt(20)
    v_mfma_f32_16x16x32_bf16 v[56:59], v[48:51], v[184:187], v[56:59]
    v_perm_b32 v48, v26, v38, v40
    v_perm_b32 v49, v26, v38, v41
    v_perm_b32 v50, v26, v38, v42
    v_perm_b32 v51, v26, v38, v43
    s_waitcnt vmcnt(19)
    v_mfma_f32_16x16x32_bf16 v[56:59], v[52:55], v[188:191], v[56:59]
    v_perm_b32 v52, v26, v38, v44
    v_perm_b32 v53, v26, v38, v45
    v_perm_b32 v54, v26, v38, v46
    v_perm_b32 v55, v26, v38, v47
    s_waitcnt vmcnt(18)
    v_mfma_f32_16x16x32_bf16 v[56:59], v[48:51], v[192:195], v[56:59]
    v_perm_b32 v48, v27, v38, v40
    v_perm_b32 v49, v27, v38, v41
    v_perm_b32 v50, v27, v38, v42
    v_perm_b32 v51, v27, v38, v43
    s_waitcnt vmcnt(17)
    v_mfma_f32_16x16x32_bf16 v[56:59], v[52:55], v[196:199], v[56:59]
    v_perm_b32 v52, v27, v38, v44
    v_perm_b32 v53, v27, v38, v45
    v_perm_b32 v54, v27, v38, v46
    v_perm_b32 v55, v27, v38, v47
    s_waitcnt vmcnt(16)
    v_mfma_f32_16x16x32_bf16 v[56:59], v[48:51], v[200:203], v[56:59]
    v_perm_b32 v48, v28, v38, v40
    v_perm_b32 v49, v28, v38, v41
    v_perm_b32 v50, v28, v38, v42
    v_perm_b32 v51, v28, v38, v43
    s_waitcnt vmcnt(15)
    v_mfma_f32_16x16x32_bf16 v[56:59], v[52:55], v[204:207], v[56:59]
    v_perm_b32 v52, v28, v38, v44
    v_perm_b32 v53, v28, v38, v45
    v_perm_b32 v54, v28, v38, v46
    v_perm_b32 v55, v28, v38, v47
    s_waitcnt vmcnt(14)
    v_mfma_f32_16x16x32_bf16 v[56:59], v[48:51], v[208:211], v[56:59]
    v_perm_b32 v48, v29, v38, v40
    v_perm_b32 v49, v29, v38, v41
    v_perm_b32 v50, v29, v38, v42
    v_perm_b32 v51, v29, v38, v43
    s_waitcnt vmcnt(13)
    v_mfma_f32_16x16x32_bf16 v[56:59], v[52:55], v[212:215], v[56:59]
    v_perm_b32 v52, v29, v38, v44
    v_perm_b32 v53, v29, v38, v45
    v_perm_b32 v54, v29, v38, v46
    v_perm_b32 v55, v29, v38, v47
    s_waitcnt vmcnt(12)
    v_mfma_f32_16x16x32_bf16 v[56:59], v[48:51], v[216:219], v[56:59]
    v_perm_b32 v48, v30, v38, v40
    v_perm_b32 v49, v30, v38, v41
    v_perm_b32 v50, v30, v38, v42
    v_perm_b32 v51, v30, v38, v43
    s_waitcnt vmcnt(11)
    v_mfma_f32_16x16x32_bf16 v[56:59], v[52:55], v[220:223], v[56:59]
    v_perm_b32 v52, v30, v38, v44
    v_perm_b32 v53, v30, v38, v45
    v_perm_b32 v54, v30, v38, v46
    v_perm_b32 v55, v30, v38, v47
    s_waitcnt vmcnt(10)
    v_mfma_f32_16x16x32_bf16 v[56:59], v[48:51], v[224:227], v[56:59]
    v_perm_b32 v48, v31, v38, v40
    v_perm_b32 v49, v31, v38, v41
    v_perm_b32 v50, v31, v38, v42
    v_perm_b32 v51, v31, v38, v43
    s_waitcnt vmcnt(9)
    v_mfma_f32_16x16x32_bf16 v[56:59], v[52:55], v[228:231], v[56:59]
    v_perm_b32 v52, v31, v38, v44
    v_perm_b32 v53, v31, v38, v45
    v_perm_b32 v54, v31, v38, v46
    v_perm_b32 v55, v31, v38, v47
    s_waitcnt vmcnt(8)
    v_mfma_f32_16x16x32_bf16 v[56:59], v[48:51], v[232:235], v[56:59]
    v_perm_b32 v48, v32, v38, v40
    v_perm_b32 v49, v32, v38, v41
    v_perm_b32 v50, v32, v38, v42
    v_perm_b32 v51, v32, v38, v43
    s_waitcnt vmcnt(7)
    v_mfma_f32_16x16x32_bf16 v[56:59], v[52:55], v[236:239], v[56:59]
    v_perm_b32 v52, v32, v38, v44
    v_perm_b32 v53, v32, v38, v45
    v_perm_b32 v54, v32, v38, v46
    v_perm_b32 v55, v32, v38, v47
    s_waitcnt vmcnt(6)
    v_mfma_f32_16x16x32_bf16 v[56:59], v[48:51], v[240:243], v[56:59]
    v_perm_b32 v48, v33, v38, v40
    v_perm_b32 v49, v33, v38, v41
    v_perm_b32 v50, v33, v38, v42
    v_perm_b32 v51, v33, v38, v43
    s_waitcnt vmcnt(5)
    v_mfma_f32_16x16x32_bf16 v[56:59], v[52:55], v[244:247], v[56:59]
    v_perm_b32 v52, v33, v38, v44
    v_perm_b32 v53, v33, v38, v45
    v_perm_b32 v54, v33, v38, v46
    v_perm_b32 v55, v33, v38, v47
    s_waitcnt vmcnt(4)
    v_mfma_f32_16x16x32_bf16 v[56:59], v[48:51], v[248:251], v[56:59]
    s_waitcnt lgkmcnt(0)
    s_or_b32 s44, s44, 0x40004000
    s_add_u32 s44, s44, 1
    s_and_b32 s44, s44, 0xbfffbfff
    s_waitcnt vmcnt(3)
    v_mfma_f32_16x16x32_bf16 v[56:59], v[52:55], v[252:255], v[56:59]
    v_mov_b32 v62, s44
    v_mov_b32 v63, s44
    s_nop 5
    v_fma_f32 v60, -v34, v58, v56
    v_fma_f32 v61, -v34, v59, v57
    v_mul_f32 v60, v60, v35
    v_mul_f32 v61, v61, v35
    s_waitcnt vmcnt(0)
    buffer_store_dwordx4 v[60:63], v39, s[40:43], s53 offen
    buffer_store_dwordx4 v[60:63], v39, s[40:43], s52 offen sc1
    s_branch L_Y2
L_Y_not0:
    s_cmp_ge_u32 s45, 4
    s_cbranch_scc1 L_S1b
    s_waitcnt lgkmcnt(0)
    s_load_dwordx2 s[28:29], s[0:1], 56
    s_load_dwordx2 s[32:33], s[0:1], 64
    s_load_dwordx2 s[36:37], s[0:1], 72
    s_load_dword s44, s[40:41], 0
    s_barrier
    s_waitcnt lgkmcnt(0)
    s_or_b32 s44, s44, 0x40004000
    s_add_u32 s44, s44, 1
    s_and_b32 s44, s44, 0xbfffbfff
    s_branch L_Y2
L_S1b:
    s_sub_u32 s54, s45, 4
    v_lshrrev_b32 v4, 5, v0
    v_xor_b32 v4, v4, v1
    v_lshlrev_b32 v4, 4, v4
    v_lshl_add_u32 v4, v2, 13, v4
    s_lshl_b32 s48, s46, 2
    s_add_u32 s48, s48, s54
    s_lshl_b32 s55, s47, 7
    s_lshl_b32 s50, s47, 18
    s_lshl_b32 s51, s48, 8
    s_add_u32 s50, s50, s51
    s_lshl_b32 s51, s54, 13
    s_add_u32 s51, s51, 0
    s_mov_b32 m0, s51
    v_and_b32 v5, 1, v2
    v_lshlrev_b32 v5, 1, v5
    v_xor_b32 v5, v5, v2
    v_lshlrev_b32 v5, 2, v5
    v_xor_b32 v6, v5, v1
    v_lshlrev_b32 v6, 4, v6
    v_lshl_add_u32 v6, v1, 9, v6
    v_add_u32 v8, s51, v6
    v_xor_b32 v9, 16, v8
    v_xor_b32 v10, 32, v8
    v_xor_b32 v11, 48, v8
    v_lshlrev_b32 v12, 4, v0
    s_lshl_b32 s52, s48, 12
    s_add_u32 s52, s52, 532480
    v_lshlrev_b32 v13, 3, v0
    v_mov_b32 v6, 2146435072
    v_cmp_gt_u32 vcc, 16, v0
    s_lshl_b32 s53, s48, 11
    s_add_u32 s53, s53, s55
    s_add_u32 s53, s53, 135168
    v_cndmask_b32 v13, v6, v13, vcc
    s_waitcnt lgkmcnt(0)
    s_load_dwordx2 s[28:29], s[0:1], 56
    s_load_dwordx2 s[32:33], s[0:1], 64
    s_load_dwordx2 s[36:37], s[0:1], 72
    s_load_dword s44, s[40:41], 0
    s_barrier
    buffer_load_dwordx4 v4, s[16:19], s50 offen nt lds
    s_add_u32 m0, m0, 1024
    s_add_u32 s50, s50, 32768
    v_xor_b32 v6, 32, v4
    buffer_load_dwordx4 v6, s[16:19], s50 offen nt lds
    s_add_u32 m0, m0, 1024
    s_add_u32 s50, s50, 32768
    v_xor_b32 v6, 64, v4
    buffer_load_dwordx4 v6, s[16:19], s50 offen nt lds
    s_add_u32 m0, m0, 1024
    s_add_u32 s50, s50, 32768
    v_xor_b32 v6, 96, v4
    buffer_load_dwordx4 v6, s[16:19], s50 offen nt lds
    s_add_u32 m0, m0, 1024
    s_add_u32 s50, s50, 32768
    v_xor_b32 v6, 128, v4
    buffer_load_dwordx4 v6, s[16:19], s50 offen nt lds
    s_add_u32 m0, m0, 1024
    s_add_u32 s50, s50, 32768
    v_xor_b32 v6, 160, v4
    buffer_load_dwordx4 v6, s[16:19], s50 offen nt lds
    s_add_u32 m0, m0, 1024
    s_add_u32 s50, s50, 32768
    v_xor_b32 v6, 192, v4
    buffer_load_dwordx4 v6, s[16:19], s50 offen nt lds
    s_add_u32 m0, m0, 1024
    s_add_u32 s50, s50, 32768
    v_xor_b32 v6, 224, v4
    buffer_load_dwordx4 v6, s[16:19], s50 offen nt lds
    s_waitcnt lgkmcnt(0)
    s_or_b32 s44, s44, 0x40004000
    s_add_u32 s44, s44, 1
    s_and_b32 s44, s44, 0xbfffbfff
    v_mov_b32 v15, s44
    s_mov_b32 s58, 65536
    s_waitcnt vmcnt(4)
    buffer_load_dwordx4 v[48:51], v12, s[40:43], s52 offen offset:0 sc1
    buffer_load_dwordx4 v[52:55], v12, s[40:43], s52 offen offset:1024 sc1
    buffer_load_dwordx4 v[56:59], v12, s[40:43], s52 offen offset:2048 sc1
    buffer_load_dwordx4 v[60:63], v12, s[40:43], s52 offen offset:3072 sc1
    s_waitcnt vmcnt(4)
    ds_read_b128 v[16:19], v8 offset:0
    ds_read_b128 v[20:23], v9 offset:0
    ds_read_b128 v[24:27], v10 offset:0
    ds_read_b128 v[28:31], v11 offset:0
    ds_read_b128 v[32:35], v8 offset:256
    ds_read_b128 v[36:39], v9 offset:256
    ds_read_b128 v[40:43], v10 offset:256
    ds_read_b128 v[44:47], v11 offset:256
L_chk_2:
    s_waitcnt vmcnt(0)
    v_bitop3_b32 v6, v50, v54, v15 bitop3:0x7e
    v_bitop3_b32 v7, v58, v62, v15 bitop3:0x7e
    v_add_f32 v50, v48, v52
    v_or_b32 v6, v6, v7
    v_add_f32 v51, v49, v53
    v_cmp_ne_u32 vcc, 0, v6
    v_add_f32 v58, v56, v60
    v_add_f32 v59, v57, v61
    s_cbranch_vccnz L_rt_3
L_ok_4:
    v_add_f32 v50, v50, v58
    v_add_f32 v51, v51, v59
    v_cvt_pk_bf16_f32 v6, v50, v51
    s_waitcnt lgkmcnt(0)
    s_nop 0
    v_mov_b32_dpp v64, v6 row_newbcast:0 row_mask:0xf bank_mask:0xf
    v_mov_b32_dpp v65, v6 row_newbcast:4 row_mask:0xf bank_mask:0xf
    v_mov_b32_dpp v66, v6 row_newbcast:8 row_mask:0xf bank_mask:0xf
    v_mov_b32_dpp v67, v6 row_newbcast:12 row_mask:0xf bank_mask:0xf
    v_mov_b32_dpp v68, v6 row_newbcast:1 row_mask:0xf bank_mask:0xf
    v_mov_b32_dpp v69, v6 row_newbcast:5 row_mask:0xf bank_mask:0xf
    v_mov_b32_dpp v70, v6 row_newbcast:9 row_mask:0xf bank_mask:0xf
    v_mov_b32_dpp v71, v6 row_newbcast:13 row_mask:0xf bank_mask:0xf
    v_mfma_f32_16x16x32_bf16 v[80:83], v[64:67], v[16:19], 0
    v_mfma_f32_16x16x32_bf16 v[84:87], v[64:67], v[32:35], 0
    v_mov_b32_dpp v72, v6 row_newbcast:2 row_mask:0xf bank_mask:0xf
    v_mov_b32_dpp v73, v6 row_newbcast:6 row_mask:0xf bank_mask:0xf
    v_mov_b32_dpp v74, v6 row_newbcast:10 row_mask:0xf bank_mask:0xf
    v_mov_b32_dpp v75, v6 row_newbcast:14 row_mask:0xf bank_mask:0xf
    v_mfma_f32_16x16x32_bf16 v[80:83], v[68:71], v[20:23], v[80:83]
    v_mfma_f32_16x16x32_bf16 v[84:87], v[68:71], v[36:39], v[84:87]
    v_mov_b32_dpp v76, v6 row_newbcast:3 row_mask:0xf bank_mask:0xf
    v_mov_b32_dpp v77, v6 row_newbcast:7 row_mask:0xf bank_mask:0xf
    v_mov_b32_dpp v78, v6 row_newbcast:11 row_mask:0xf bank_mask:0xf
    v_mov_b32_dpp v79, v6 row_newbcast:15 row_mask:0xf bank_mask:0xf
    v_mfma_f32_16x16x32_bf16 v[80:83], v[72:75], v[24:27], v[80:83]
    v_mfma_f32_16x16x32_bf16 v[84:87], v[72:75], v[40:43], v[84:87]
    v_mfma_f32_16x16x32_bf16 v[80:83], v[76:79], v[28:31], v[80:83]
    v_mfma_f32_16x16x32_bf16 v[84:87], v[76:79], v[44:47], v[84:87]
    s_nop 7
    v_cvt_pk_bf16_f32 v14, v80, v84
    buffer_store_dwordx2 v[14:15], v13, s[40:43], s53 offen sc1
L_Y2:
    s_barrier
    s_cmp_lt_u32 s47, 9
    s_cbranch_scc1 L_S4
    s_sub_u32 s56, s47, 2
    s_cmp_ge_u32 s45, 4
    s_cselect_b32 s50, 7, 0
    s_sub_u32 s56, s56, s50
    s_cmp_lt_u32 s56, 9
    s_cbranch_scc1 L_S3b
    s_lshl_b32 s50, s47, 2
    s_add_u32 s50, s50, s45
    s_sub_u32 s50, s50, 44
    s_cmp_eq_u32 s46, 3
    s_cselect_b32 s55, 18, 9
    s_cmp_ge_u32 s50, s55
    s_cbranch_scc1 L_end
    s_sub_u32 s51, 3, s46
    s_and_b32 s51, s51, 7
    s_cmp_ge_u32 s50, 9
    s_cselect_b32 s51, 8, s51
    s_cselect_b32 s52, 9, 0
    s_sub_u32 s52, s50, s52
    s_mul_i32 s52, s52, 589824
    s_mul_i32 s53, s46, 9
    s_add_u32 s51, s51, s53
    s_lshl_b32 s51, s51, 7
    s_add_u32 s52, s52, s51
    v_mul_u32_u24 v4, 9216, v0
    buffer_load_dword v8, v4, s[28:31], s52 offen
L_end:
    s_endpgm
L_rt_3:
    s_cmp_eq_u32 s58, 0
    s_cbranch_scc1 L_ok_4
    s_sub_u32 s58, s58, 1
    s_cmp_eq_u32 s58, 65504
    s_cselect_b32 s57, 528384, 0
    s_sub_u32 s52, s52, s57
    buffer_load_dwordx4 v[48:51], v12, s[40:43], s52 offen offset:0 sc1
    buffer_load_dwordx4 v[52:55], v12, s[40:43], s52 offen offset:1024 sc1
    buffer_load_dwordx4 v[56:59], v12, s[40:43], s52 offen offset:2048 sc1
    buffer_load_dwordx4 v[60:63], v12, s[40:43], s52 offen offset:3072 sc1
    s_branch L_chk_2
L_S3b:
    s_and_b32 s54, s45, 3
    v_lshrrev_b32 v4, 3, v0
    v_mul_u32_u24 v4, 1152, v4
    v_and_b32 v5, 7, v0
    v_lshl_add_u32 v4, v5, 4, v4
    s_lshl_b32 s50, s46, 2
    s_add_u32 s52, s50, s54
    s_mul_i32 s50, s52, 147456
    s_lshl_b32 s53, s56, 7
    s_add_u32 s50, s50, s53
    s_mul_i32 s51, s45, 16640
    s_add_u32 m0, s51, 0
    s_mov_b32 s57, 15
L_dma_5:
    buffer_load_dwordx4 v4, s[24:27], s50 offen nt lds
    s_add_u32 m0, m0, 1040
    s_add_u32 s50, s50, 9216
    s_sub_u32 s57, s57, 1
    s_cbranch_scc0 L_dma_5
    v_bfe_u32 v5, v1, 2, 1
    v_lshl_add_u32 v5, v2, 1, v5
    v_mul_u32_u24 v5, 2080, v5
    v_lshrrev_b32 v6, 3, v1
    v_lshl_add_u32 v5, v6, 7, v5
    v_and_b32 v6, 3, v1
    v_lshl_add_u32 v5, v6, 3, v5
    v_add_u32 v5, s51, v5
    v_lshrrev_b32 v7, 2, v1
    v_lshl_add_u32 v7, v7, 3, v2
    v_lshlrev_b32 v7, 7, v7
    v_lshl_add_u32 v7, v6, 4, v7
    s_lshl_b32 s52, s52, 12
    s_add_u32 s52, s52, 401920
    v_lshlrev_b32 v8, 2, v0
    s_cmp_eq_u32 s46, 0
    s_cselect_b32 s55, s53, 4096
    v_add_u32 v9, s55, v8
    buffer_load_dword v12, v9, s[4:7], 0 offen
    s_lshl_b32 s55, s45, 8
    s_add_u32 s55, s55, 153856
    v_add_u32 v9, s55, v8
    v_lshlrev_b32 v10, 3, v0
    v_and_b32 v10, 0xff, v10
    v_add_u32 v10, s55, v10
    v_mov_b32 v11, 2146435072
    v_cmp_gt_u32 vcc, 32, v0
    s_mul_i32 s55, s46, 1152
    s_add_u32 s53, s53, s55
    s_add_u32 s53, s53, 200704
    v_cndmask_b32 v8, v11, v8, vcc
    v_mov_b32 v15, -1
    s_waitcnt vmcnt(0)
    v_and_b32 v13, 0xffff0000, v12
    v_lshlrev_b32 v12, 16, v12
    buffer_load_dwordx4 v[144:147], v7, s[40:43], s52 offen sc1
    ds_read_b64_tr_b16 v[16:17], v5 offset:0
    ds_read_b64_tr_b16 v[18:19], v5 offset:256
    ds_read_b64_tr_b16 v[20:21], v5 offset:512
    ds_read_b64_tr_b16 v[22:23], v5 offset:768
    ds_read_b64_tr_b16 v[24:25], v5 offset:1040
    ds_read_b64_tr_b16 v[26:27], v5 offset:1296
    ds_read_b64_tr_b16 v[28:29], v5 offset:1552
    ds_read_b64_tr_b16 v[30:31], v5 offset:1808
    ds_read_b64_tr_b16 v[32:33], v5 offset:32
    ds_read_b64_tr_b16 v[34:35], v5 offset:288
    ds_read_b64_tr_b16 v[36:37], v5 offset:544
    ds_read_b64_tr_b16 v[38:39], v5 offset:800
    ds_read_b64_tr_b16 v[40:41], v5 offset:1072
    ds_read_b64_tr_b16 v[42:43], v5 offset:1328
    ds_read_b64_tr_b16 v[44:45], v5 offset:1584
    ds_read_b64_tr_b16 v[46:47], v5 offset:1840
    ds_read_b64_tr_b16 v[48:49], v5 offset:64
    ds_read_b64_tr_b16 v[50:51], v5 offset:320
    ds_read_b64_tr_b16 v[52:53], v5 offset:576
    ds_read_b64_tr_b16 v[54:55], v5 offset:832
    ds_read_b64_tr_b16 v[56:57], v5 offset:1104
    ds_read_b64_tr_b16 v[58:59], v5 offset:1360
    ds_read_b64_tr_b16 v[60:61], v5 offset:1616
    ds_read_b64_tr_b16 v[62:63], v5 offset:1872
    ds_read_b64_tr_b16 v[64:65], v5 offset:96
    ds_read_b64_tr_b16 v[66:67], v5 offset:352
    ds_read_b64_tr_b16 v[68:69], v5 offset:608
    ds_read_b64_tr_b16 v[70:71], v5 offset:864
    ds_read_b64_tr_b16 v[72:73], v5 offset:1136
    ds_read_b64_tr_b16 v[74:75], v5 offset:1392
    ds_read_b64_tr_b16 v[76:77], v5 offset:1648
    ds_read_b64_tr_b16 v[78:79], v5 offset:1904
    s_waitcnt lgkmcnt(0)
    s_mov_b32 s58, 65536
L_chk_6:
    s_waitcnt vmcnt(0)
    v_max3_u32 v6, v144, v145, v146
    v_max_u32 v6, v6, v147
    v_cmp_eq_u32 vcc, v15, v6
    s_cbranch_vccnz L_rt_7
L_ok_8:
    v_mfma_f32_16x16x32_bf16 v[80:83], v[144:147], v[16:19], 0
    v_mfma_f32_16x16x32_bf16 v[84:87], v[144:147], v[20:23], 0
    v_mfma_f32_16x16x32_bf16 v[88:91], v[144:147], v[24:27], 0
    v_mfma_f32_16x16x32_bf16 v[92:95], v[144:147], v[28:31], 0
    v_mfma_f32_16x16x32_bf16 v[96:99], v[144:147], v[32:35], 0
    v_mfma_f32_16x16x32_bf16 v[100:103], v[144:147], v[36:39], 0
    v_mfma_f32_16x16x32_bf16 v[104:107], v[144:147], v[40:43], 0
    v_mfma_f32_16x16x32_bf16 v[108:111], v[144:147], v[44:47], 0
    v_mfma_f32_16x16x32_bf16 v[112:115], v[144:147], v[48:51], 0
    v_mfma_f32_16x16x32_bf16 v[116:119], v[144:147], v[52:55], 0
    v_mfma_f32_16x16x32_bf16 v[120:123], v[144:147], v[56:59], 0
    v_mfma_f32_16x16x32_bf16 v[124:127], v[144:147], v[60:63], 0
    v_add_f32 v80, v80, v85
    v_add_f32 v90, v90, v95
    v_add_f32 v80, v80, v90
    v_mfma_f32_16x16x32_bf16 v[128:131], v[144:147], v[64:67], 0
    v_mfma_f32_16x16x32_bf16 v[132:135], v[144:147], v[68:71], 0
    v_mfma_f32_16x16x32_bf16 v[136:139], v[144:147], v[72:75], 0
    v_mfma_f32_16x16x32_bf16 v[140:143], v[144:147], v[76:79], 0
    v_add_f32 v96, v96, v101
    v_add_f32 v106, v106, v111
    v_add_f32 v96, v96, v106
    s_nop 0
    v_add_f32 v112, v112, v117
    v_add_f32 v122, v122, v127
    v_add_f32 v112, v112, v122
    s_nop 0
    v_add_f32 v128, v128, v133
    v_add_f32 v138, v138, v143
    v_add_f32 v128, v128, v138
    s_nop 1
    v_permlane32_swap_b32 v80, v112
    v_permlane32_swap_b32 v96, v128
    v_add_f32 v80, v80, v112
    v_add_f32 v96, v96, v128
    s_nop 1
    v_permlane16_swap_b32 v80, v96
    v_add_f32 v80, v80, v96
    ds_write_b32 v9, v80
    s_cmp_lg_u32 s54, 0
    s_waitcnt lgkmcnt(0)
    s_barrier
    s_cbranch_scc1 L_end
    ds_read2_b64 v[80:83], v10 offset0:0 offset1:32
    ds_read2_b64 v[84:87], v10 offset0:64 offset1:96
    s_waitcnt lgkmcnt(1)
    v_pk_add_f32 v[12:13], v[12:13], v[80:81]
    v_pk_add_f32 v[12:13], v[12:13], v[82:83]
    s_waitcnt lgkmcnt(0)
    v_pk_add_f32 v[84:85], v[84:85], v[86:87]
    v_pk_add_f32 v[12:13], v[12:13], v[84:85]
    v_cvt_pk_bf16_f32 v6, v12, v13
    buffer_store_dword v6, v8, s[40:43], s53 offen sc1
    s_endpgm
L_rt_7:
    s_cmp_eq_u32 s58, 0
    s_cbranch_scc1 L_ok_8
    s_sub_u32 s58, s58, 1
    s_cmp_eq_u32 s58, 65408
    s_cselect_b32 s57, 512, 0
    s_sub_u32 s52, s52, s57
    buffer_load_dwordx4 v[144:147], v7, s[40:43], s52 offen sc1
    s_branch L_chk_6
L_S4:
    s_mul_i32 s56, s46, 9
    s_add_u32 s56, s56, s47
    s_cmp_ge_u32 s45, 3
    s_cbranch_scc1 L_S4_w2
    v_lshrrev_b32 v4, 3, v0
    v_and_b32 v5, 2, v4
    v_and_b32 v6, 7, v0
    v_xor_b32 v5, v5, v6
    v_mul_u32_u24 v4, 9216, v4
    v_lshl_add_u32 v4, v5, 4, v4
    s_mul_i32 s52, s45, 1769472
    s_lshl_b32 s53, s56, 7
    s_add_u32 s52, s52, s53
    s_mul_i32 s53, s45, 25344
    s_add_u32 m0, s53, 0
    s_mov_b32 s57, 23
L_dma_9:
    buffer_load_dwordx4 v4, s[28:31], s52 offen nt lds
    s_add_u32 m0, m0, 1056
    s_add_u32 s52, s52, 73728
    s_sub_u32 s57, s57, 1
    s_cbranch_scc0 L_dma_9
    s_branch L_S4_set
L_S4_w2:
    s_cmp_ge_u32 s45, 6
    s_cbranch_scc1 L_S4_set
    s_sub_u32 s50, s45, 3
    s_mul_i32 s53, s50, 192
    v_lshrrev_b32 v4, 3, v0
    v_add_u32 v4, s53, v4
    v_lshlrev_b32 v7, 4, v0
    s_mul_i32 s52, s56, 73728
    s_mul_i32 s53, s50, 24576
    s_add_u32 s52, s52, s53
    s_add_u32 m0, s53, 76032
    s_mov_b32 s57, 23
L_dma_10:
    v_mul_u32_u24 v5, 7282, v4
    v_bfe_u32 v6, v5, 17, 1
    v_bfe_u32 v5, v5, 19, 1
    v_lshl_add_u32 v5, v5, 1, v6
    v_lshlrev_b32 v5, 5, v5
    v_xor_b32 v5, v5, v7
    v_add_u32 v4, 8, v4
    buffer_load_dwordx4 v5, s[32:35], s52 offen nt lds
    s_add_u32 m0, m0, 1024
    s_add_u32 s52, s52, 1024
    s_sub_u32 s57, s57, 1
    s_cbranch_scc0 L_dma_10
L_S4_set:
    v_lshrrev_b32 v4, 2, v1
    v_and_b32 v5, 3, v1
    v_lshl_add_u32 v6, v2, 3, v4
    v_mul_u32_u24 v6, 1152, v6
    v_lshl_add_u32 v6, v5, 3, v6
    v_add_u32 v6, 76032, v6
    v_and_b32 v7, 1, v2
    v_lshrrev_b32 v3, 3, v1
    v_lshl_add_u32 v7, v7, 1, v3
    s_min_u32 s50, s45, 4
    s_lshl_b32 s51, s45, 2
    s_add_u32 s50, s50, s51
    v_xor_b32 v8, s50, v7
    v_lshl_add_u32 v132, v8, 5, v6
    s_add_u32 s50, s50, 1
    v_xor_b32 v8, s50, v7
    v_lshl_add_u32 v133, v8, 5, v6
    s_add_u32 s50, s50, 1
    v_xor_b32 v8, s50, v7
    v_lshl_add_u32 v134, v8, 5, v6
    s_add_u32 s50, s50, 1
    v_xor_b32 v8, s50, v7
    v_lshl_add_u32 v135, v8, 5, v6
    s_add_u32 s50, s50, 1
    v_xor_b32 v8, s50, v7
    v_lshl_add_u32 v136, v8, 5, v6
    s_add_u32 s50, s50, 1
    v_and_b32 v7, 7, v1
    v_lshl_add_u32 v7, v2, 3, v7
    v_lshl_add_u32 v7, v3, 5, v7
    v_lshlrev_b32 v7, 2, v7
    v_add_u32 v7, 153856, v7
    v_mov_b32 v8, 154880
    v_lshlrev_b32 v9, 4, v0
    v_mov_b32 v10, 2146435072
    v_cmp_gt_u32 vcc, 16, v0
    s_lshl_b32 s54, s56, 3
    s_add_u32 s54, s54, s45
    s_lshl_b32 s54, s54, 8
    s_add_u32 s54, s54, 212992
    v_cndmask_b32 v9, v10, v9, vcc
    s_cmp_ge_u32 s45, 3
    s_cbranch_scc1 L_S4_hi
    v_mul_u32_u24 v10, 2112, v2
    v_lshl_add_u32 v10, v4, 7, v10
    v_lshl_add_u32 v10, v5, 3, v10
    s_mul_i32 s50, s45, 25344
    s_add_u32 s50, s50, 0
    v_add_u32 v10, s50, v10
    v_xor_b32 v13, 1, v3
    v_lshl_add_u32 v13, v13, 5, v10
    v_lshl_add_u32 v10, v3, 5, v10
    v_mov_b32 v56, 0x3f803f80
    v_mov_b32 v57, 0x3f803f80
    v_mov_b32 v58, 0x3f803f80
    v_mov_b32 v59, 0x3f803f80
    v_lshrrev_b32 v11, 1, v1
    v_mul_u32_u24 v11, 1152, v11
    v_and_b32 v12, 1, v1
    v_cmp_ne_u32 s[52:53], 0, v12
    v_lshl_add_u32 v12, v2, 1, v12
    v_lshl_add_u32 v11, v12, 4, v11
    s_mul_i32 s51, s45, 384
    s_add_u32 s51, s51, 200704
    s_lshl_b32 s50, s45, 8
    s_add_u32 s50, s50, 153856
    v_lshl_add_u32 v12, v0, 2, s50
    v_mov_b32 v15, -1
    s_waitcnt vmcnt(16)
    ds_read_b64_tr_b16 v[140:141], v10 offset:0
    ds_read_b64_tr_b16 v[142:143], v10 offset:512
    ds_read_b64_tr_b16 v[144:145], v13 offset:0
    ds_read_b64_tr_b16 v[146:147], v13 offset:512
    ds_read_b64_tr_b16 v[148:149], v10 offset:64
    ds_read_b64_tr_b16 v[150:151], v10 offset:576
    ds_read_b64_tr_b16 v[152:153], v13 offset:64
    ds_read_b64_tr_b16 v[154:155], v13 offset:576
    ds_read_b64_tr_b16 v[156:157], v10 offset:1056
    ds_read_b64_tr_b16 v[158:159], v10 offset:1568
    ds_read_b64_tr_b16 v[160:161], v13 offset:1056
    ds_read_b64_tr_b16 v[162:163], v13 offset:1568
    ds_read_b64_tr_b16 v[164:165], v10 offset:1120
    ds_read_b64_tr_b16 v[166:167], v10 offset:1632
    ds_read_b64_tr_b16 v[168:169], v13 offset:1120
    ds_read_b64_tr_b16 v[170:171], v13 offset:1632
    s_waitcnt vmcnt(8)
    ds_read_b64_tr_b16 v[172:173], v10 offset:8448
    ds_read_b64_tr_b16 v[174:175], v10 offset:8960
    ds_read_b64_tr_b16 v[176:177], v13 offset:8448
    ds_read_b64_tr_b16 v[178:179], v13 offset:8960
    ds_read_b64_tr_b16 v[180:181], v10 offset:8512
    ds_read_b64_tr_b16 v[182:183], v10 offset:9024
    ds_read_b64_tr_b16 v[184:185], v13 offset:8512
    ds_read_b64_tr_b16 v[186:187], v13 offset:9024
    ds_read_b64_tr_b16 v[188:189], v10 offset:9504
    ds_read_b64_tr_b16 v[190:191], v10 offset:10016
    ds_read_b64_tr_b16 v[192:193], v13 offset:9504
    ds_read_b64_tr_b16 v[194:195], v13 offset:10016
    ds_read_b64_tr_b16 v[196:197], v10 offset:9568
    ds_read_b64_tr_b16 v[198:199], v10 offset:10080
    ds_read_b64_tr_b16 v[200:201], v13 offset:9568
    ds_read_b64_tr_b16 v[202:203], v13 offset:10080
    s_waitcnt vmcnt(0)
    ds_read_b64_tr_b16 v[204:205], v10 offset:16896
    ds_read_b64_tr_b16 v[206:207], v10 offset:17408
    ds_read_b64_tr_b16 v[208:209], v13 offset:16896
    ds_read_b64_tr_b16 v[210:211], v13 offset:17408
    ds_read_b64_tr_b16 v[212:213], v10 offset:16960
    ds_read_b64_tr_b16 v[214:215], v10 offset:17472
    ds_read_b64_tr_b16 v[216:217], v13 offset:16960
    ds_read_b64_tr_b16 v[218:219], v13 offset:17472
    ds_read_b64_tr_b16 v[220:221], v10 offset:17952
    ds_read_b64_tr_b16 v[222:223], v10 offset:18464
    ds_read_b64_tr_b16 v[224:225], v13 offset:17952
    ds_read_b64_tr_b16 v[226:227], v13 offset:18464
    ds_read_b64_tr_b16 v[228:229], v10 offset:18016
    ds_read_b64_tr_b16 v[230:231], v10 offset:18528
    ds_read_b64_tr_b16 v[232:233], v13 offset:18016
    ds_read_b64_tr_b16 v[234:235], v13 offset:18528
    s_waitcnt lgkmcnt(0)
    v_mfma_f32_16x16x32_bf16 v[80:83], v[56:59], v[140:143], 0
    v_mfma_f32_16x16x32_bf16 v[84:87], v[56:59], v[144:147], 0
    v_mfma_f32_16x16x32_bf16 v[88:91], v[56:59], v[148:151], 0
    v_mfma_f32_16x16x32_bf16 v[92:95], v[56:59], v[152:155], 0
    v_mfma_f32_16x16x32_bf16 v[80:83], v[56:59], v[156:159], v[80:83]
    v_mfma_f32_16x16x32_bf16 v[84:87], v[56:59], v[160:163], v[84:87]
    v_mfma_f32_16x16x32_bf16 v[88:91], v[56:59], v[164:167], v[88:91]
    v_mfma_f32_16x16x32_bf16 v[92:95], v[56:59], v[168:171], v[92:95]
    v_mfma_f32_16x16x32_bf16 v[80:83], v[56:59], v[172:175], v[80:83]
    v_mfma_f32_16x16x32_bf16 v[84:87], v[56:59], v[176:179], v[84:87]
    v_mfma_f32_16x16x32_bf16 v[88:91], v[56:59], v[180:183], v[88:91]
    v_mfma_f32_16x16x32_bf16 v[92:95], v[56:59], v[184:187], v[92:95]
    v_mfma_f32_16x16x32_bf16 v[80:83], v[56:59], v[188:191], v[80:83]
    v_mfma_f32_16x16x32_bf16 v[84:87], v[56:59], v[192:195], v[84:87]
    v_mfma_f32_16x16x32_bf16 v[88:91], v[56:59], v[196:199], v[88:91]
    v_mfma_f32_16x16x32_bf16 v[92:95], v[56:59], v[200:203], v[92:95]
    v_mfma_f32_16x16x32_bf16 v[80:83], v[56:59], v[204:207], v[80:83]
    v_mfma_f32_16x16x32_bf16 v[84:87], v[56:59], v[208:211], v[84:87]
    v_mfma_f32_16x16x32_bf16 v[88:91], v[56:59], v[212:215], v[88:91]
    v_mfma_f32_16x16x32_bf16 v[92:95], v[56:59], v[216:219], v[92:95]
    v_mfma_f32_16x16x32_bf16 v[80:83], v[56:59], v[220:223], v[80:83]
    v_mfma_f32_16x16x32_bf16 v[84:87], v[56:59], v[224:227], v[84:87]
    v_mfma_f32_16x16x32_bf16 v[88:91], v[56:59], v[228:231], v[88:91]
    v_mfma_f32_16x16x32_bf16 v[92:95], v[56:59], v[232:235], v[92:95]
    s_nop 7
    v_permlane32_swap_b32 v80, v88
    v_permlane32_swap_b32 v84, v92
    s_nop 1
    v_permlane16_swap_b32 v80, v84
    ds_write_b32 v12, v80 offset:2048
    s_waitcnt lgkmcnt(0)
    s_barrier
    buffer_load_dwordx4 v[60:63], v11, s[40:43], s51 offen offset:0 sc1
    buffer_load_dwordx4 v[64:67], v11, s[40:43], s51 offen offset:128 sc1
    buffer_load_dwordx4 v[68:71], v11, s[40:43], s51 offen offset:256 sc1
    ds_read_b64_tr_b16 v[16:17], v132 offset:0
    ds_read_b64_tr_b16 v[18:19], v132 offset:4608
    ds_read_b64_tr_b16 v[20:21], v132 offset:36864
    ds_read_b64_tr_b16 v[22:23], v132 offset:41472
    ds_read_b64_tr_b16 v[24:25], v133 offset:0
    ds_read_b64_tr_b16 v[26:27], v133 offset:4608
    ds_read_b64_tr_b16 v[28:29], v133 offset:36864
    ds_read_b64_tr_b16 v[30:31], v133 offset:41472
    ds_read_b64_tr_b16 v[32:33], v134 offset:0
    ds_read_b64_tr_b16 v[34:35], v134 offset:4608
    ds_read_b64_tr_b16 v[36:37], v134 offset:36864
    ds_read_b64_tr_b16 v[38:39], v134 offset:41472
    ds_read_b64_tr_b16 v[40:41], v135 offset:0
    ds_read_b64_tr_b16 v[42:43], v135 offset:4608
    ds_read_b64_tr_b16 v[44:45], v135 offset:36864
    ds_read_b64_tr_b16 v[46:47], v135 offset:41472
    ds_read_b64_tr_b16 v[48:49], v136 offset:0
    ds_read_b64_tr_b16 v[50:51], v136 offset:4608
    ds_read_b64_tr_b16 v[52:53], v136 offset:36864
    ds_read_b64_tr_b16 v[54:55], v136 offset:41472
    ds_read2st64_b32 v[112:113], v7 offset0:8 offset1:9
    ds_read_b32 v14, v7 offset:2560
    s_waitcnt lgkmcnt(0)
    v_add_f32 v14, v14, v112
    v_add_f32 v14, v14, v113
    s_mov_b32 s58, 65536
L_chk_11:
    s_waitcnt vmcnt(2)
    v_max3_u32 v13, v60, v61, v62
    v_max_u32 v13, v13, v63
    v_cmp_eq_u32 vcc, v15, v13
    s_cbranch_vccnz L_rt_12
L_ok_13:
    v_mfma_f32_16x16x32_bf16 v[72:75], v[60:63], v[60:63], 0
    v_mfma_f32_16x16x32_bf16 v[76:79], v[60:63], v[56:59], 0
    v_mfma_f32_16x16x32_bf16 v[80:83], v[60:63], v[140:143], 0
    v_mfma_f32_16x16x32_bf16 v[84:87], v[60:63], v[156:159], 0
    v_mfma_f32_16x16x32_bf16 v[88:91], v[60:63], v[144:147], 0
    v_mfma_f32_16x16x32_bf16 v[92:95], v[60:63], v[160:163], 0
    v_mfma_f32_16x16x32_bf16 v[96:99], v[60:63], v[148:151], 0
    v_mfma_f32_16x16x32_bf16 v[100:103], v[60:63], v[164:167], 0
    v_mfma_f32_16x16x32_bf16 v[104:107], v[60:63], v[152:155], 0
    v_mfma_f32_16x16x32_bf16 v[108:111], v[60:63], v[168:171], 0
    s_waitcnt vmcnt(1)
    v_max3_u32 v13, v64, v65, v66
    v_max_u32 v13, v13, v67
    v_cmp_eq_u32 vcc, v15, v13
    s_cbranch_vccnz L_rt_14
L_ok_15:
    v_mfma_f32_16x16x32_bf16 v[72:75], v[64:67], v[64:67], v[72:75]
    v_mfma_f32_16x16x32_bf16 v[76:79], v[64:67], v[56:59], v[76:79]
    v_mfma_f32_16x16x32_bf16 v[80:83], v[64:67], v[172:175], v[80:83]
    v_mfma_f32_16x16x32_bf16 v[84:87], v[64:67], v[188:191], v[84:87]
    v_mfma_f32_16x16x32_bf16 v[88:91], v[64:67], v[176:179], v[88:91]
    v_mfma_f32_16x16x32_bf16 v[92:95], v[64:67], v[192:195], v[92:95]
    v_mfma_f32_16x16x32_bf16 v[96:99], v[64:67], v[180:183], v[96:99]
    v_mfma_f32_16x16x32_bf16 v[100:103], v[64:67], v[196:199], v[100:103]
    v_mfma_f32_16x16x32_bf16 v[104:107], v[64:67], v[184:187], v[104:107]
    v_mfma_f32_16x16x32_bf16 v[108:111], v[64:67], v[200:203], v[108:111]
    s_waitcnt vmcnt(0)
    v_max3_u32 v13, v68, v69, v70
    v_max_u32 v13, v13, v71
    v_cmp_eq_u32 vcc, v15, v13
    s_cbranch_vccnz L_rt_16
L_ok_17:
    v_mfma_f32_16x16x32_bf16 v[72:75], v[68:71], v[68:71], v[72:75]
    v_mfma_f32_16x16x32_bf16 v[76:79], v[68:71], v[56:59], v[76:79]
    v_mfma_f32_16x16x32_bf16 v[80:83], v[68:71], v[204:207], v[80:83]
    v_mfma_f32_16x16x32_bf16 v[84:87], v[68:71], v[220:223], v[84:87]
    v_mfma_f32_16x16x32_bf16 v[88:91], v[68:71], v[208:211], v[88:91]
    v_mfma_f32_16x16x32_bf16 v[92:95], v[68:71], v[224:227], v[92:95]
    v_mfma_f32_16x16x32_bf16 v[96:99], v[68:71], v[212:215], v[96:99]
    v_mfma_f32_16x16x32_bf16 v[100:103], v[68:71], v[228:231], v[100:103]
    v_mfma_f32_16x16x32_bf16 v[104:107], v[68:71], v[216:219], v[104:107]
    v_add_f32 v72, v72, v74
    v_add_f32 v73, v73, v75
    v_mfma_f32_16x16x32_bf16 v[108:111], v[68:71], v[232:235], v[108:111]
    v_cndmask_b32 v72, v72, v73, s[52:53]
    v_add_f32 v76, v76, v77
    v_add_f32 v78, v78, v79
    v_add_f32_dpp v72, v72, v72 row_ror:1 row_mask:0xf bank_mask:0xf
    v_add_f32 v80, v80, v82
    v_add_f32 v85, v85, v87
    v_add_f32_dpp v72, v72, v72 row_ror:2 row_mask:0xf bank_mask:0xf
    v_add_f32 v80, v80, v85
    v_add_f32 v88, v88, v90
    v_add_f32_dpp v72, v72, v72 row_ror:4 row_mask:0xf bank_mask:0xf
    v_add_f32 v93, v93, v95
    v_add_f32 v88, v88, v93
    v_add_f32_dpp v72, v72, v72 row_ror:8 row_mask:0xf bank_mask:0xf
    v_add_f32 v76, v76, v78
    v_add_f32 v96, v96, v98
    v_add_f32 v101, v101, v103
    v_permlane32_swap_b32 v76, v72
    v_add_f32 v96, v96, v101
    v_add_f32 v104, v104, v106
    v_add_f32 v109, v109, v111
    v_permlane32_swap_b32 v80, v96
    v_add_f32 v104, v104, v109
    v_add_f32 v76, v76, v72
    v_add_f32 v80, v80, v96
    v_permlane32_swap_b32 v88, v104
    ds_write_b32 v12, v76 offset:1024
    v_add_f32 v88, v88, v104
    s_nop 1
    v_permlane16_swap_b32 v80, v88
    v_add_f32 v80, v80, v88
    ds_write_b32 v12, v80
    s_waitcnt lgkmcnt(0)
L_S4_p2:
    s_barrier
    ds_read2_b32 v[112:113], v8 offset0:0 offset1:32
    ds_read2_b32 v[114:115], v8 offset0:16 offset1:48
    ds_read2_b32 v[116:117], v8 offset0:64 offset1:96
    ds_read2_b32 v[118:119], v8 offset0:80 offset1:112
    ds_read2_b32 v[120:121], v8 offset0:128 offset1:160
    ds_read2_b32 v[122:123], v8 offset0:144 offset1:176
    ds_read2st64_b32 v[124:125], v7 offset0:0 offset1:1
    ds_read_b32 v126, v7 offset:512
    s_waitcnt lgkmcnt(4)
    v_pk_add_f32 v[112:113], v[112:113], v[114:115]
    v_pk_add_f32 v[116:117], v[116:117], v[118:119]
    s_waitcnt lgkmcnt(2)
    v_pk_add_f32 v[120:121], v[120:121], v[122:123]
    v_pk_add_f32 v[112:113], v[112:113], v[116:117]
    v_pk_add_f32 v[112:113], v[112:113], v[120:121]
    v_mul_f32 v112, 0x3ae38e39, v112
    v_mul_f32 v113, 0x3ae38e39, v113
    v_fma_f32 v113, -v112, v112, v113
    v_add_f32 v113, 0x3727c5ac, v113
    v_rsq_f32 v113, v113
    s_waitcnt lgkmcnt(0)
    v_add_f32 v124, v124, v125
    v_fma_f32 v126, -v112, v14, v126
    v_add_f32 v124, v124, v126
    v_mul_f32 v124, v124, v113
    v_mul_f32 v125, 0xbfb8aa3b, v124
    v_exp_f32 v125, v125
    v_mov_b32 v131, s44
    v_add_f32 v125, 1.0, v125
    v_rcp_f32 v125, v125
    v_mov_b32 v130, 0
    v_mul_f32 v124, v124, v125
    s_cmp_ge_u32 s45, 4
    s_nop 0
    v_mov_b32_dpp v125, v124 quad_perm:[1,1,3,3] row_mask:0xf bank_mask:0xf
    v_cvt_pk_bf16_f32 v124, v124, v125
    s_nop 1
    v_mov_b32_dpp v112, v124 row_newbcast:0 row_mask:0xf bank_mask:0xf
    v_mov_b32_dpp v113, v124 row_newbcast:2 row_mask:0xf bank_mask:0xf
    v_mov_b32_dpp v114, v124 row_newbcast:4 row_mask:0xf bank_mask:0xf
    v_mov_b32_dpp v115, v124 row_newbcast:6 row_mask:0xf bank_mask:0xf
    v_mov_b32_dpp v116, v124 row_newbcast:8 row_mask:0xf bank_mask:0xf
    v_mov_b32_dpp v117, v124 row_newbcast:10 row_mask:0xf bank_mask:0xf
    v_mov_b32_dpp v118, v124 row_newbcast:12 row_mask:0xf bank_mask:0xf
    v_mov_b32_dpp v119, v124 row_newbcast:14 row_mask:0xf bank_mask:0xf
    v_mfma_f32_16x16x32_bf16 v[80:83], v[112:115], v[16:19], 0
    v_mfma_f32_16x16x32_bf16 v[84:87], v[112:115], v[24:27], 0
    v_mfma_f32_16x16x32_bf16 v[88:91], v[112:115], v[32:35], 0
    v_mfma_f32_16x16x32_bf16 v[92:95], v[112:115], v[40:43], 0
    s_cbranch_scc1 L_t4_18
    v_mfma_f32_16x16x32_bf16 v[96:99], v[112:115], v[48:51], 0
    v_mfma_f32_16x16x32_bf16 v[96:99], v[116:119], v[52:55], v[96:99]
L_t4_18:
    v_mfma_f32_16x16x32_bf16 v[80:83], v[116:119], v[20:23], v[80:83]
    v_mfma_f32_16x16x32_bf16 v[84:87], v[116:119], v[28:31], v[84:87]
    v_mfma_f32_16x16x32_bf16 v[88:91], v[116:119], v[36:39], v[88:91]
    v_mfma_f32_16x16x32_bf16 v[92:95], v[116:119], v[44:47], v[92:95]
    s_nop 2
    s_cbranch_scc1 L_t4_19
    v_cvt_pk_bf16_f32 v130, v96, v96
L_t4_19:
    s_nop 1
    v_cvt_pk_bf16_f32 v128, v80, v84
    s_nop 0
    v_cvt_pk_bf16_f32 v129, v88, v92
    buffer_store_dwordx4 v[128:131], v9, s[40:43], s54 offen sc1
    s_endpgm
L_rt_12:
    s_cmp_eq_u32 s58, 0
    s_cbranch_scc1 L_ok_13
    s_sub_u32 s58, s58, 1
    s_waitcnt vmcnt(0)
    buffer_load_dwordx4 v[60:63], v11, s[40:43], s51 offen offset:0 sc1
    buffer_load_dwordx4 v[64:67], v11, s[40:43], s51 offen offset:128 sc1
    buffer_load_dwordx4 v[68:71], v11, s[40:43], s51 offen offset:256 sc1
    s_branch L_chk_11
L_rt_14:
    s_cmp_eq_u32 s58, 0
    s_cbranch_scc1 L_ok_15
    s_sub_u32 s58, s58, 1
    s_waitcnt vmcnt(0)
    buffer_load_dwordx4 v[60:63], v11, s[40:43], s51 offen offset:0 sc1
    buffer_load_dwordx4 v[64:67], v11, s[40:43], s51 offen offset:128 sc1
    buffer_load_dwordx4 v[68:71], v11, s[40:43], s51 offen offset:256 sc1
    s_branch L_chk_11
L_rt_16:
    s_cmp_eq_u32 s58, 0
    s_cbranch_scc1 L_ok_17
    s_sub_u32 s58, s58, 1
    s_waitcnt vmcnt(0)
    buffer_load_dwordx4 v[60:63], v11, s[40:43], s51 offen offset:0 sc1
    buffer_load_dwordx4 v[64:67], v11, s[40:43], s51 offen offset:128 sc1
    buffer_load_dwordx4 v[68:71], v11, s[40:43], s51 offen offset:256 sc1
    s_branch L_chk_11
L_S4_hi:
    s_waitcnt vmcnt(0)
    s_cmp_lg_u32 s45, 5
    s_cbranch_scc1 L_nocc_20
    s_mov_b32 s58, 65536
    v_and_b32 v10, 1, v0
    v_lshlrev_b32 v10, 8, v10
    s_and_b32 s59, s2, 63
    s_mul_i32 s59, s59, 640
    s_add_u32 s59, s59, 360448
    buffer_load_dword v60, v10, s[40:43], s59 offen offset:8 sc1
L_chk_21:
    s_waitcnt vmcnt(0)
    v_cmp_ne_u32 vcc, s44, v60
    s_cbranch_vccnz L_rt_22
L_ok_23:
L_nocc_20:
    s_barrier
    ds_read_b64_tr_b16 v[16:17], v132 offset:0
    ds_read_b64_tr_b16 v[18:19], v132 offset:4608
    ds_read_b64_tr_b16 v[20:21], v132 offset:36864
    ds_read_b64_tr_b16 v[22:23], v132 offset:41472
    ds_read_b64_tr_b16 v[24:25], v133 offset:0
    ds_read_b64_tr_b16 v[26:27], v133 offset:4608
    ds_read_b64_tr_b16 v[28:29], v133 offset:36864
    ds_read_b64_tr_b16 v[30:31], v133 offset:41472
    ds_read_b64_tr_b16 v[32:33], v134 offset:0
    ds_read_b64_tr_b16 v[34:35], v134 offset:4608
    ds_read_b64_tr_b16 v[36:37], v134 offset:36864
    ds_read_b64_tr_b16 v[38:39], v134 offset:41472
    ds_read_b64_tr_b16 v[40:41], v135 offset:0
    ds_read_b64_tr_b16 v[42:43], v135 offset:4608
    ds_read_b64_tr_b16 v[44:45], v135 offset:36864
    ds_read_b64_tr_b16 v[46:47], v135 offset:41472
    s_cmp_ge_u32 s45, 4
    s_cbranch_scc1 L_t4_24
    ds_read_b64_tr_b16 v[48:49], v136 offset:0
    ds_read_b64_tr_b16 v[50:51], v136 offset:4608
    ds_read_b64_tr_b16 v[52:53], v136 offset:36864
    ds_read_b64_tr_b16 v[54:55], v136 offset:41472
L_t4_24:
    ds_read2st64_b32 v[112:113], v7 offset0:8 offset1:9
    ds_read_b32 v14, v7 offset:2560
    s_waitcnt lgkmcnt(0)
    v_add_f32 v14, v14, v112
    v_add_f32 v14, v14, v113
    s_branch L_S4_p2
L_rt_22:
    s_cmp_eq_u32 s58, 0
    s_cbranch_scc1 L_ok_23
    s_sub_u32 s58, s58, 1
    s_sleep 4
    buffer_load_dword v60, v10, s[40:43], s59 offen offset:8 sc1
    s_branch L_chk_21
L_X:
    s_sub_u32 s47, s47, 16
    s_lshl_b32 s56, s46, 4
    s_add_u32 s56, s56, s47
    s_lshr_b32 s48, s56, 1
    s_and_b32 s49, s47, 1
    s_cmp_ge_u32 s45, 4
    s_cbranch_scc1 L_PV
    v_lshlrev_b32 v4, 4, v0
    s_lshl_b32 s50, s48, 17
    s_lshl_b32 s51, s45, 15
    s_add_u32 s50, s50, s51
    s_mul_i32 s51, s45, 33280
    s_mov_b32 m0, s51
    v_and_b32 v5, 7, v1
    v_lshrrev_b32 v6, 3, v1
    v_lshl_add_u32 v5, v5, 1, v6
    v_mul_u32_u24 v5, 1040, v5
    v_lshl_add_u32 v5, v2, 8, v5
    v_add_u32 v5, s51, v5
    v_mul_u32_u24 v6, 1040, v1
    v_lshl_add_u32 v6, v2, 8, v6
    v_add_u32 v6, 133120, v6
    v_lshlrev_b32 v7, 2, v1
    v_add_u32 v7, 153856, v7
    s_lshl_b32 s52, s45, 10
    s_add_u32 s52, s52, 149760
    v_add_u32 v8, s52, v4
    v_mov_b32 v9, 0xff800000
    v_mul_u32_u24 v3, 80, v1
    v_add_u32 v3, 155264, v3
    s_lshl_b32 s52, s45, 4
    v_lshl_add_u32 v10, v2, 2, s52
    v_add_u32 v10, v10, v3
    s_waitcnt lgkmcnt(0)
    s_load_dwordx2 s[28:29], s[0:1], 56
    s_load_dwordx2 s[32:33], s[0:1], 64
    s_load_dwordx2 s[36:37], s[0:1], 72
    s_load_dword s44, s[40:41], 0
    s_waitcnt lgkmcnt(0)
    s_or_b32 s44, s44, 0x40004000
    s_add_u32 s44, s44, 1
    s_and_b32 s44, s44, 0xbfffbfff
    s_mov_b32 s57, 7
L_dma_25:
    buffer_load_dwordx4 v4, s[8:11], s50 offen nt lds
    s_add_u32 m0, m0, 1040
    s_add_u32 s50, s50, 1024
    s_sub_u32 s57, s57, 1
    s_cbranch_scc0 L_dma_25
    v_mov_b32 v11, 2146435072
    v_cmp_gt_u32 vcc, 16, v0
    v_lshlrev_b32 v43, 2, v0
    s_mul_i32 s51, s48, 640
    s_lshl_b32 s54, s49, 8
    s_add_u32 s51, s51, s54
    s_add_u32 s51, s51, 360448
    v_cndmask_b32 v43, v11, v43, vcc
    v_cndmask_b32 v11, v11, v4, vcc
    v_and_b32 v46, 1, v1
    v_lshlrev_b32 v46, 4, v46
    v_mov_b32 v47, 0xffff
    v_lshlrev_b32 v47, v46, v47
    v_bfe_u32 v46, v1, 1, 2
    v_cmp_eq_u32 vcc, 0, v46
    s_nop 1
    v_cndmask_b32 v32, 0, v47, vcc
    v_cmp_eq_u32 vcc, 1, v46
    s_nop 1
    v_cndmask_b32 v33, 0, v47, vcc
    v_cmp_eq_u32 vcc, 2, v46
    s_nop 1
    v_cndmask_b32 v34, 0, v47, vcc
    v_cmp_eq_u32 vcc, 3, v46
    s_nop 1
    v_cndmask_b32 v35, 0, v47, vcc
    v_and_b32 v45, 1, v2
    v_lshrrev_b32 v46, 2, v1
    v_lshl_add_u32 v47, v46, 1, v45
    s_lshl_b32 s54, s45, 1
    v_xor_b32 v47, s54, v47
    v_lshlrev_b32 v47, 5, v47
    v_lshl_add_u32 v47, v46, 12, v47
    v_lshl_add_u32 v47, v2, 8, v47
    v_and_b32 v46, 3, v0
    v_lshl_add_u32 v36, v46, 3, v47
    v_xor_b32 v37, 32, v36
    v_and_b32 v38, 12, v1
    v_add_u32 v38, v38, v2
    v_mul_u32_u24 v38, 640, v38
    s_lshl_b32 s54, s45, 2
    s_add_u32 s54, s54, 156544
    v_mov_b32 v39, s54
    v_mov_b32 v40, 156544
    s_mul_i32 s54, s45, 320
    s_add_u32 s54, s54, 153984
    v_lshlrev_b32 v45, 3, v45
    v_lshl_add_u32 v45, v1, 4, v45
    v_add_u32 v41, s54, v45
    v_mul_u32_u24 v42, 320, v46
    v_lshl_add_u32 v42, v2, 4, v42
    v_add_u32 v42, 153984, v42
    v_mov_b32 v44, 0x10001
    s_lshr_b32 s54, s56, 2
    s_lshl_b32 s54, s54, 4
    s_mul_i32 s55, s45, 10240
    s_add_u32 s54, s54, s55
    s_add_u32 s54, s54, 360448
    s_lshl_b32 s55, s56, 3
    s_add_u32 s55, s55, s45
    s_lshl_b32 s55, s55, 7
    s_add_u32 s55, s55, 401408
    s_lshl_b32 s59, s56, 2
    s_add_u32 s59, s59, s45
    s_lshl_b32 s59, s59, 12
    s_add_u32 s59, s59, 1048576
    s_bfe_u32 s60, s44, 0x20000
    s_mul_i32 s60, s60, 0x8001
    s_and_b32 s60, s60, 0x10001
    s_bfe_u32 s61, s44, 0x20002
    s_mul_i32 s61, s61, 0x8001
    s_and_b32 s61, s61, 0x10001
    s_bfe_u32 s62, s44, 0x20004
    s_mul_i32 s62, s62, 0x8001
    s_and_b32 s62, s62, 0x10001
    s_xor_b32 s63, s60, 0x10001
    s_xor_b32 s60, s60, 0x10001
    s_xor_b32 s61, s61, 0x10001
    s_xor_b32 s62, s62, 0x10001
    s_xor_b32 s63, s63, 0x10001
    v_mov_b32 v14, s44
    v_mov_b32 v15, s44
    ds_write_b32 v7, v9
    s_mov_b32 s57, 23
L_dma_26:
    buffer_load_dwordx4 v4, s[8:11], s50 offen nt lds
    s_add_u32 m0, m0, 1040
    s_add_u32 s50, s50, 1024
    s_sub_u32 s57, s57, 1
    s_cbranch_scc0 L_dma_26
    s_waitcnt vmcnt(16)
    ds_read_b128 v[128:131], v5 offset:0
    ds_read_b128 v[132:135], v5 offset:16
    ds_read_b128 v[136:139], v5 offset:32
    ds_read_b128 v[140:143], v5 offset:48
    ds_read_b128 v[144:147], v5 offset:64
    ds_read_b128 v[148:151], v5 offset:80
    ds_read_b128 v[152:155], v5 offset:96
    ds_read_b128 v[156:159], v5 offset:112
    ds_read_b128 v[160:163], v5 offset:128
    ds_read_b128 v[164:167], v5 offset:144
    ds_read_b128 v[168:171], v5 offset:160
    ds_read_b128 v[172:175], v5 offset:176
    ds_read_b128 v[176:179], v5 offset:192
    ds_read_b128 v[180:183], v5 offset:208
    ds_read_b128 v[184:187], v5 offset:224
    ds_read_b128 v[188:191], v5 offset:240
    s_waitcnt vmcnt(3)
    s_barrier
    s_waitcnt vmcnt(0)
    ds_read_b128 v[192:195], v5 offset:16640
    ds_read_b128 v[196:199], v5 offset:16656
    ds_read_b128 v[200:203], v5 offset:16672
    ds_read_b128 v[204:207], v5 offset:16688
    ds_read_b128 v[208:211], v5 offset:16704
    ds_read_b128 v[212:215], v5 offset:16720
    ds_read_b128 v[216:219], v5 offset:16736
    ds_read_b128 v[220:223], v5 offset:16752
    ds_read_b128 v[224:227], v5 offset:16768
    ds_read_b128 v[228:231], v5 offset:16784
    ds_read_b128 v[232:235], v5 offset:16800
    ds_read_b128 v[236:239], v5 offset:16816
    ds_read_b128 v[240:243], v5 offset:16832
    ds_read_b128 v[244:247], v5 offset:16848
    ds_read_b128 v[248:251], v5 offset:16864
    ds_read_b128 v[252:255], v5 offset:16880
    s_waitcnt lgkmcnt(0)
    s_barrier
    ds_read_b128 v[64:67], v6 offset:0
    ds_read_b128 v[68:71], v6 offset:16
    ds_read_b128 v[72:75], v6 offset:32
    ds_read_b128 v[76:79], v6 offset:48
    ds_read_b128 v[80:83], v6 offset:64
    ds_read_b128 v[84:87], v6 offset:80
    ds_read_b128 v[88:91], v6 offset:96
    ds_read_b128 v[92:95], v6 offset:112
    ds_read_b128 v[96:99], v6 offset:128
    ds_read_b128 v[100:103], v6 offset:144
    ds_read_b128 v[104:107], v6 offset:160
    ds_read_b128 v[108:111], v6 offset:176
    s_waitcnt lgkmcnt(11)
    v_mfma_f32_16x16x32_bf16 v[16:19], v[128:131], v[64:67], 0
    v_mfma_f32_16x16x32_bf16 v[20:23], v[192:195], v[64:67], 0
    ds_read_b128 v[112:115], v6 offset:192
    s_waitcnt lgkmcnt(11)
    v_mfma_f32_16x16x32_bf16 v[16:19], v[132:135], v[68:71], v[16:19]
    v_mfma_f32_16x16x32_bf16 v[20:23], v[196:199], v[68:71], v[20:23]
    ds_read_b128 v[116:119], v6 offset:208
    s_waitcnt lgkmcnt(11)
    v_mfma_f32_16x16x32_bf16 v[16:19], v[136:139], v[72:75], v[16:19]
    v_mfma_f32_16x16x32_bf16 v[20:23], v[200:203], v[72:75], v[20:23]
    ds_read_b128 v[120:123], v6 offset:224
    s_waitcnt lgkmcnt(11)
    v_mfma_f32_16x16x32_bf16 v[16:19], v[140:143], v[76:79], v[16:19]
    v_mfma_f32_16x16x32_bf16 v[20:23], v[204:207], v[76:79], v[20:23]
    ds_read_b128 v[124:127], v6 offset:240
    s_waitcnt lgkmcnt(11)
    v_mfma_f32_16x16x32_bf16 v[16:19], v[144:147], v[80:83], v[16:19]
    v_mfma_f32_16x16x32_bf16 v[20:23], v[208:211], v[80:83], v[20:23]
    s_waitcnt lgkmcnt(10)
    v_mfma_f32_16x16x32_bf16 v[16:19], v[148:151], v[84:87], v[16:19]
    v_mfma_f32_16x16x32_bf16 v[20:23], v[212:215], v[84:87], v[20:23]
    s_waitcnt lgkmcnt(9)
    v_mfma_f32_16x16x32_bf16 v[16:19], v[152:155], v[88:91], v[16:19]
    v_mfma_f32_16x16x32_bf16 v[20:23], v[216:219], v[88:91], v[20:23]
    s_waitcnt lgkmcnt(8)
    v_mfma_f32_16x16x32_bf16 v[16:19], v[156:159], v[92:95], v[16:19]
    v_mfma_f32_16x16x32_bf16 v[20:23], v[220:223], v[92:95], v[20:23]
    s_waitcnt lgkmcnt(7)
    v_mfma_f32_16x16x32_bf16 v[16:19], v[160:163], v[96:99], v[16:19]
    v_mfma_f32_16x16x32_bf16 v[20:23], v[224:227], v[96:99], v[20:23]
    s_waitcnt lgkmcnt(6)
    v_mfma_f32_16x16x32_bf16 v[16:19], v[164:167], v[100:103], v[16:19]
    v_mfma_f32_16x16x32_bf16 v[20:23], v[228:231], v[100:103], v[20:23]
    s_waitcnt lgkmcnt(5)
    v_mfma_f32_16x16x32_bf16 v[16:19], v[168:171], v[104:107], v[16:19]
    v_mfma_f32_16x16x32_bf16 v[20:23], v[232:235], v[104:107], v[20:23]
    s_waitcnt lgkmcnt(4)
    v_mfma_f32_16x16x32_bf16 v[16:19], v[172:175], v[108:111], v[16:19]
    v_mfma_f32_16x16x32_bf16 v[20:23], v[236:239], v[108:111], v[20:23]
    s_waitcnt lgkmcnt(3)
    v_mfma_f32_16x16x32_bf16 v[16:19], v[176:179], v[112:115], v[16:19]
    v_mfma_f32_16x16x32_bf16 v[20:23], v[240:243], v[112:115], v[20:23]
    s_waitcnt lgkmcnt(2)
    v_mfma_f32_16x16x32_bf16 v[16:19], v[180:183], v[116:119], v[16:19]
    v_mfma_f32_16x16x32_bf16 v[20:23], v[244:247], v[116:119], v[20:23]
    s_waitcnt lgkmcnt(1)
    v_mfma_f32_16x16x32_bf16 v[16:19], v[184:187], v[120:123], v[16:19]
    v_mfma_f32_16x16x32_bf16 v[20:23], v[248:251], v[120:123], v[20:23]
    s_waitcnt lgkmcnt(0)
    v_mfma_f32_16x16x32_bf16 v[16:19], v[188:191], v[124:127], v[16:19]
    v_mfma_f32_16x16x32_bf16 v[20:23], v[252:255], v[124:127], v[20:23]
    s_nop 6
    v_max3_f32 v9, v16, v17, v18
    v_max3_f32 v9, v9, v19, v20
    v_max3_f32 v9, v9, v21, v22
    v_max_f32 v9, v9, v23
    ds_max_f32 v7, v9
    s_waitcnt lgkmcnt(0)
    s_barrier
    ds_read_b32 v12, v7
    s_waitcnt lgkmcnt(0)
    v_sub_f32 v16, v16, v12
    v_sub_f32 v17, v17, v12
    v_sub_f32 v18, v18, v12
    v_sub_f32 v19, v19, v12
    v_sub_f32 v20, v20, v12
    v_sub_f32 v21, v21, v12
    v_sub_f32 v22, v22, v12
    v_sub_f32 v23, v23, v12
    v_exp_f32 v16, v16
    v_exp_f32 v17, v17
    v_exp_f32 v18, v18
    v_exp_f32 v19, v19
    v_exp_f32 v20, v20
    v_exp_f32 v21, v21
    v_exp_f32 v22, v22
    v_exp_f32 v23, v23
    v_cvt_pk_bf16_f32 v24, v16, v17
    v_cvt_pk_bf16_f32 v25, v18, v19
    v_cvt_pk_bf16_f32 v26, v20, v21
    v_cvt_pk_bf16_f32 v27, v22, v23
    ds_write_b128 v8, v[24:27]
    v_pk_add_f32 v[16:17], v[16:17], v[18:19]
    v_pk_add_f32 v[20:21], v[20:21], v[22:23]
    v_pk_add_f32 v[16:17], v[16:17], v[20:21]
    v_add_f32 v16, v16, v17
    ds_write_b32 v10, v16
    s_cmp_lg_u32 s45, 0
    s_waitcnt lgkmcnt(0)
    s_barrier
    s_cbranch_scc1 L_nostat_27
    s_setprio 3
    ds_read_b128 v[16:19], v3 offset:0
    ds_read_b128 v[20:23], v3 offset:16
    ds_read_b128 v[24:27], v3 offset:32
    ds_read_b128 v[28:31], v3 offset:48
    s_waitcnt lgkmcnt(3)
    v_add_f32 v16, v16, v17
    v_add_f32 v18, v18, v19
    v_add_f32 v13, v16, v18
    s_waitcnt lgkmcnt(2)
    v_add_f32 v20, v20, v21
    v_add_f32 v22, v22, v23
    v_add_f32 v13, v13, v20
    v_add_f32 v13, v13, v22
    s_waitcnt lgkmcnt(1)
    v_add_f32 v24, v24, v25
    v_add_f32 v26, v26, v27
    v_add_f32 v13, v13, v24
    v_add_f32 v13, v13, v26
    s_waitcnt lgkmcnt(0)
    v_add_f32 v28, v28, v29
    v_add_f32 v30, v30, v31
    v_add_f32 v13, v13, v28
    v_add_f32 v13, v13, v30
    buffer_store_dwordx4 v[12:15], v11, s[40:43], s51 offen sc1
    s_setprio 0
L_nostat_27:
    s_barrier
    buffer_load_dwordx4 v[136:139], v38, s[40:43], s54 offen sc1
    ds_read_b64_tr_b16 v[64:65], v36 offset:0
    ds_read_b64_tr_b16 v[66:67], v36 offset:33280
    ds_read_b64_tr_b16 v[68:69], v36 offset:1024
    ds_read_b64_tr_b16 v[70:71], v36 offset:34304
    ds_read_b64_tr_b16 v[72:73], v36 offset:2048
    ds_read_b64_tr_b16 v[74:75], v36 offset:35328
    ds_read_b64_tr_b16 v[76:77], v36 offset:3072
    ds_read_b64_tr_b16 v[78:79], v36 offset:36352
    ds_read_b64_tr_b16 v[80:81], v37 offset:0
    ds_read_b64_tr_b16 v[82:83], v37 offset:33280
    ds_read_b64_tr_b16 v[84:85], v37 offset:1024
    ds_read_b64_tr_b16 v[86:87], v37 offset:34304
    ds_read_b64_tr_b16 v[88:89], v37 offset:2048
    ds_read_b64_tr_b16 v[90:91], v37 offset:35328
    ds_read_b64_tr_b16 v[92:93], v37 offset:3072
    ds_read_b64_tr_b16 v[94:95], v37 offset:36352
    s_mov_b32 s58, 65536
L_chk_28:
    s_waitcnt vmcnt(0)
    v_cmp_ne_u32 vcc, s44, v138
    s_cbranch_vccnz L_rt_29
L_ok_30:
    buffer_load_dwordx4 v[96:99], v4, s[40:43], s59 offen offset:0 sc1
    buffer_load_dwordx4 v[100:103], v4, s[40:43], s59 offen offset:1024 sc1
    buffer_load_dwordx4 v[104:107], v4, s[40:43], s59 offen offset:2048 sc1
    buffer_load_dwordx4 v[108:111], v4, s[40:43], s59 offen offset:3072 sc1
    v_mov_b32 v143, v136
    s_nop 1
    v_max_f32_dpp v143, v143, v143 row_ror:4 row_mask:0xf bank_mask:0xf
    s_nop 1
    v_max_f32_dpp v143, v143, v143 row_ror:8 row_mask:0xf bank_mask:0xf
    v_mov_b32 v141, v143
    s_nop 1
    v_permlane16_swap_b32 v143, v141
    v_max_f32 v143, v143, v141
    v_mov_b32 v141, v143
    s_nop 1
    v_permlane32_swap_b32 v143, v141
    v_max_f32 v143, v143, v141
    v_sub_f32 v140, v136, v143
    v_exp_f32 v140, v140
    s_nop 0
    v_cvt_pk_bf16_f32 v140, v140, v140
    v_and_b32 v142, 0xffff0000, v140
    v_mul_f32 v142, v142, v137
    v_and_b32_dpp v112, v140, v32 row_newbcast:0 row_mask:0xf bank_mask:0xf
    v_and_b32_dpp v113, v140, v33 row_newbcast:0 row_mask:0xf bank_mask:0xf
    v_and_b32_dpp v114, v140, v34 row_newbcast:0 row_mask:0xf bank_mask:0xf
    v_and_b32_dpp v115, v140, v35 row_newbcast:0 row_mask:0xf bank_mask:0xf
    v_and_b32_dpp v116, v140, v32 row_newbcast:4 row_mask:0xf bank_mask:0xf
    v_and_b32_dpp v117, v140, v33 row_newbcast:4 row_mask:0xf bank_mask:0xf
    v_and_b32_dpp v118, v140, v34 row_newbcast:4 row_mask:0xf bank_mask:0xf
    v_and_b32_dpp v119, v140, v35 row_newbcast:4 row_mask:0xf bank_mask:0xf
    v_and_b32_dpp v120, v140, v32 row_newbcast:8 row_mask:0xf bank_mask:0xf
    v_and_b32_dpp v121, v140, v33 row_newbcast:8 row_mask:0xf bank_mask:0xf
    v_and_b32_dpp v122, v140, v34 row_newbcast:8 row_mask:0xf bank_mask:0xf
    v_and_b32_dpp v123, v140, v35 row_newbcast:8 row_mask:0xf bank_mask:0xf
    v_and_b32_dpp v124, v140, v32 row_newbcast:12 row_mask:0xf bank_mask:0xf
    v_and_b32_dpp v125, v140, v33 row_newbcast:12 row_mask:0xf bank_mask:0xf
    v_and_b32_dpp v126, v140, v34 row_newbcast:12 row_mask:0xf bank_mask:0xf
    v_and_b32_dpp v127, v140, v35 row_newbcast:12 row_mask:0xf bank_mask:0xf
    s_nop 1
    v_add_f32_dpp v142, v142, v142 row_ror:4 row_mask:0xf bank_mask:0xf
    s_nop 1
    v_add_f32_dpp v142, v142, v142 row_ror:8 row_mask:0xf bank_mask:0xf
    v_mov_b32 v141, v142
    s_nop 1
    v_permlane16_swap_b32 v142, v141
    v_add_f32 v142, v142, v141
    v_mov_b32 v141, v142
    s_nop 1
    v_permlane32_swap_b32 v142, v141
    v_add_f32 v142, v142, v141
    ds_write2_b32 v39, v143, v142 offset0:0 offset1:4
    s_mov_b32 s58, 65536
L_chk_31:
    s_waitcnt vmcnt(3)
    v_xor_b32 v96, s60, v96
    v_xor_b32 v97, s61, v97
    v_xor_b32 v98, s62, v98
    v_xor_b32 v99, s63, v99
    v_bitop3_b32 v6, v44, v96, v97 bitop3:0x80
    v_bitop3_b32 v6, v6, v98, v99 bitop3:0x80
    v_mfma_f32_16x16x32_bf16 v[128:131], v[112:115], v[96:99], 0
    s_waitcnt vmcnt(2)
    v_xor_b32 v100, s60, v100
    v_xor_b32 v101, s61, v101
    v_xor_b32 v102, s62, v102
    v_xor_b32 v103, s63, v103
    v_bitop3_b32 v6, v6, v100, v101 bitop3:0x80
    v_bitop3_b32 v6, v6, v102, v103 bitop3:0x80
    v_mfma_f32_16x16x32_bf16 v[128:131], v[116:119], v[100:103], v[128:131]
    s_waitcnt vmcnt(1)
    v_xor_b32 v104, s60, v104
    v_xor_b32 v105, s61, v105
    v_xor_b32 v106, s62, v106
    v_xor_b32 v107, s63, v107
    v_bitop3_b32 v6, v6, v104, v105 bitop3:0x80
    v_bitop3_b32 v6, v6, v106, v107 bitop3:0x80
    v_mfma_f32_16x16x32_bf16 v[128:131], v[120:123], v[104:107], v[128:131]
    s_waitcnt vmcnt(0)
    v_xor_b32 v108, s60, v108
    v_xor_b32 v109, s61, v109
    v_xor_b32 v110, s62, v110
    v_xor_b32 v111, s63, v111
    v_bitop3_b32 v6, v6, v108, v109 bitop3:0x80
    v_bitop3_b32 v6, v6, v110, v111 bitop3:0x80
    v_mfma_f32_16x16x32_bf16 v[128:131], v[124:127], v[108:111], v[128:131]
    v_cmp_ne_u32 vcc, v44, v6
    s_cbranch_vccnz L_rt_32
L_ok_33:
    s_nop 5
    v_cvt_pk_bf16_f32 v132, v128, v129
    v_cvt_pk_bf16_f32 v133, v130, v131
    ds_write_b64 v41, v[132:133]
    s_waitcnt lgkmcnt(0)
    s_barrier
    ds_read_b128 v[112:115], v42 offset:0
    ds_read_b128 v[136:139], v40
    ds_read_b128 v[140:143], v40 offset:16
    ds_read_b128 v[116:119], v42 offset:64
    ds_read_b128 v[120:123], v42 offset:128
    ds_read_b128 v[124:127], v42 offset:192
    s_waitcnt lgkmcnt(5)
    v_mfma_f32_16x16x32_bf16 v[128:131], v[112:115], v[64:67], 0
    v_mfma_f32_16x16x32_bf16 v[132:135], v[112:115], v[80:83], 0
    s_waitcnt lgkmcnt(2)
    v_max3_f32 v6, v136, v137, v138
    v_max_f32 v6, v6, v139
    v_mfma_f32_16x16x32_bf16 v[128:131], v[116:119], v[68:71], v[128:131]
    v_sub_f32 v136, v136, v6
    v_sub_f32 v137, v137, v6
    v_mfma_f32_16x16x32_bf16 v[132:135], v[116:119], v[84:87], v[132:135]
    v_sub_f32 v138, v138, v6
    v_sub_f32 v139, v139, v6
    s_waitcnt lgkmcnt(1)
    v_mfma_f32_16x16x32_bf16 v[128:131], v[120:123], v[72:75], v[128:131]
    v_exp_f32 v136, v136
    v_mfma_f32_16x16x32_bf16 v[132:135], v[120:123], v[88:91], v[132:135]
    v_exp_f32 v137, v137
    s_waitcnt lgkmcnt(0)
    v_mfma_f32_16x16x32_bf16 v[128:131], v[124:127], v[76:79], v[128:131]
    v_exp_f32 v138, v138
    v_mfma_f32_16x16x32_bf16 v[132:135], v[124:127], v[92:95], v[132:135]
    v_exp_f32 v139, v139
    v_mul_f32 v6, v136, v140
    v_fmac_f32 v6, v137, v141
    v_fmac_f32 v6, v138, v142
    v_fmac_f32 v6, v139, v143
    v_rcp_f32 v6, v6
    v_mul_f32 v128, v128, v136
    v_fmac_f32 v128, v129, v137
    v_mul_f32 v132, v132, v136
    v_fmac_f32 v128, v130, v138
    v_fmac_f32 v132, v133, v137
    v_fmac_f32 v128, v131, v139
    v_fmac_f32 v132, v134, v138
    v_mul_f32 v128, v128, v6
    v_fmac_f32 v132, v135, v139
    v_mul_f32 v132, v132, v6
    v_cvt_pk_bf16_f32 v6, v128, v132
    buffer_store_dword v6, v43, s[40:43], s55 offen offset:512
    buffer_store_dword v6, v43, s[40:43], s55 offen sc1
    s_endpgm
L_rt_29:
    s_cmp_eq_u32 s58, 0
    s_cbranch_scc1 L_ok_30
    s_sub_u32 s58, s58, 1
    s_sleep 1
    buffer_load_dwordx4 v[136:139], v38, s[40:43], s54 offen sc1
    s_branch L_chk_28
L_rt_32:
    s_cmp_eq_u32 s58, 0
    s_cbranch_scc1 L_ok_33
    s_sub_u32 s58, s58, 1
    buffer_load_dwordx4 v[96:99], v4, s[40:43], s59 offen offset:0 sc1
    buffer_load_dwordx4 v[100:103], v4, s[40:43], s59 offen offset:1024 sc1
    buffer_load_dwordx4 v[104:107], v4, s[40:43], s59 offen offset:2048 sc1
    buffer_load_dwordx4 v[108:111], v4, s[40:43], s59 offen offset:3072 sc1
    s_branch L_chk_31
L_PV:
    s_sub_u32 s54, s45, 4
    v_lshlrev_b32 v4, 18, v2
    v_lshl_add_u32 v4, v1, 4, v4
    s_lshl_b32 s50, s49, 20
    s_lshl_b32 s51, s54, 14
    s_add_u32 s50, s50, s51
    s_lshl_b32 s51, s48, 8
    s_add_u32 s50, s50, s51
    s_add_u32 s50, s50, 1048576
    s_add_u32 s51, s50, 65536
    s_add_u32 s52, s50, 131072
    s_add_u32 s53, s50, 196608
    s_waitcnt lgkmcnt(0)
    s_load_dwordx2 s[28:29], s[0:1], 56
    s_load_dwordx2 s[32:33], s[0:1], 64
    s_load_dwordx2 s[36:37], s[0:1], 72
    s_load_dword s44, s[40:41], 0
    v_and_b32 v96, 1, v2
    v_lshlrev_b32 v5, 3, v96
    v_lshrrev_b32 v6, 2, v1
    v_lshl_add_u32 v5, v6, 1, v5
    v_lshrrev_b32 v6, 1, v2
    v_add_u32 v5, v5, v6
    v_mul_u32_u24 v5, 1040, v5
    v_and_b32 v6, 3, v1
    v_lshl_add_u32 v5, v6, 3, v5
    s_lshl_b32 s55, s54, 8
    v_add_u32 v5, s55, v5
    v_add_u32 v6, 66560, v5
    v_lshlrev_b32 v7, 4, v0
    v_add_u32 v12, 4096, v7
    v_add_u32 v13, 149760, v7
    s_mul_i32 s55, s54, 4160
    s_add_u32 s55, s55, 133120
    v_lshl_add_u32 v8, v0, 3, s55
    v_add_u32 v9, 1040, v8
    v_add_u32 v10, 2080, v8
    v_add_u32 v11, 3120, v8
    s_lshl_b32 s55, s54, 2
    v_lshl_add_u32 v96, v96, 1, s55
    v_xor_b32 v96, v96, v1
    v_lshlrev_b32 v96, 4, v96
    v_lshl_add_u32 v96, v2, 13, v96
    s_and_b32 s59, s56, 3
    s_lshl_b32 s59, s59, 20
    s_lshr_b32 s55, s56, 2
    s_lshl_b32 s55, s55, 8
    s_add_u32 s59, s59, s55
    s_lshl_b32 s55, s54, 17
    s_add_u32 s59, s59, s55
    s_lshl_b32 m0, s54, 12
    s_lshl_b32 s55, s49, 15
    s_lshl_b32 s57, s54, 13
    s_add_u32 s55, s55, s57
    s_add_u32 s55, s55, 135168
    s_waitcnt lgkmcnt(0)
    s_or_b32 s44, s44, 0x40004000
    s_add_u32 s44, s44, 1
    s_and_b32 s44, s44, 0xbfffbfff
    s_bfe_u32 s60, s44, 0x20000
    s_mul_i32 s60, s60, 0x8001
    s_and_b32 s60, s60, 0x10001
    s_bfe_u32 s61, s44, 0x20002
    s_mul_i32 s61, s61, 0x8001
    s_and_b32 s61, s61, 0x10001
    s_bfe_u32 s62, s44, 0x20004
    s_mul_i32 s62, s62, 0x8001
    s_and_b32 s62, s62, 0x10001
    s_xor_b32 s63, s60, 0x10001
    v_mov_b32 v15, s44
    v_mov_b32 v14, 0xfffefffe
    v_mov_b32 v3, 0x07060302
    s_mov_b32 s58, 65536
    s_barrier
    buffer_load_dwordx4 v[16:19], v7, s[40:43], s55 offen offset:0 sc1
    buffer_load_dwordx4 v[20:23], v7, s[40:43], s55 offen offset:1024 sc1
    buffer_load_dwordx4 v[24:27], v7, s[40:43], s55 offen offset:2048 sc1
    buffer_load_dwordx4 v[28:31], v7, s[40:43], s55 offen offset:3072 sc1
    buffer_load_dwordx4 v[32:35], v12, s[40:43], s55 offen offset:0 sc1
    buffer_load_dwordx4 v[36:39], v12, s[40:43], s55 offen offset:1024 sc1
    buffer_load_dwordx4 v[40:43], v12, s[40:43], s55 offen offset:2048 sc1
    buffer_load_dwordx4 v[44:47], v12, s[40:43], s55 offen offset:3072 sc1
    ds_read_b64_tr_b16 v[128:129], v5 offset:0
    ds_read_b64_tr_b16 v[144:145], v5 offset:32
    ds_read_b64_tr_b16 v[160:161], v5 offset:64
    ds_read_b64_tr_b16 v[176:177], v5 offset:96
    ds_read_b64_tr_b16 v[192:193], v5 offset:128
    ds_read_b64_tr_b16 v[208:209], v5 offset:160
    ds_read_b64_tr_b16 v[224:225], v5 offset:192
    ds_read_b64_tr_b16 v[240:241], v5 offset:224
    ds_read_b64_tr_b16 v[132:133], v5 offset:33280
    ds_read_b64_tr_b16 v[148:149], v5 offset:33312
    ds_read_b64_tr_b16 v[164:165], v5 offset:33344
    ds_read_b64_tr_b16 v[180:181], v5 offset:33376
    ds_read_b64_tr_b16 v[196:197], v5 offset:33408
    ds_read_b64_tr_b16 v[212:213], v5 offset:33440
    ds_read_b64_tr_b16 v[228:229], v5 offset:33472
    ds_read_b64_tr_b16 v[244:245], v5 offset:33504
    ds_read_b64_tr_b16 v[136:137], v6 offset:0
    ds_read_b64_tr_b16 v[152:153], v6 offset:32
    ds_read_b64_tr_b16 v[168:169], v6 offset:64
    ds_read_b64_tr_b16 v[184:185], v6 offset:96
    ds_read_b64_tr_b16 v[200:201], v6 offset:128
    ds_read_b64_tr_b16 v[216:217], v6 offset:160
    ds_read_b64_tr_b16 v[232:233], v6 offset:192
    ds_read_b64_tr_b16 v[248:249], v6 offset:224
    ds_read_b64_tr_b16 v[140:141], v6 offset:33280
    ds_read_b64_tr_b16 v[156:157], v6 offset:33312
    ds_read_b64_tr_b16 v[172:173], v6 offset:33344
    ds_read_b64_tr_b16 v[188:189], v6 offset:33376
    ds_read_b64_tr_b16 v[204:205], v6 offset:33408
    ds_read_b64_tr_b16 v[220:221], v6 offset:33440
    ds_read_b64_tr_b16 v[236:237], v6 offset:33472
    ds_read_b64_tr_b16 v[252:253], v6 offset:33504
L_chk_34:
    s_waitcnt vmcnt(7)
    v_bitop3_b32 v48, v17, v19, v15 bitop3:0x7e
    ds_write2_b32 v8, v16, v18 offset0:0 offset1:1
    s_waitcnt vmcnt(6)
    v_bitop3_b32 v49, v21, v23, v15 bitop3:0x7e
    ds_write2_b32 v8, v20, v22 offset0:128 offset1:129
    s_waitcnt vmcnt(5)
    v_bitop3_b32 v50, v25, v27, v15 bitop3:0x7e
    ds_write2_b32 v9, v24, v26 offset0:0 offset1:1
    s_waitcnt vmcnt(4)
    v_bitop3_b32 v51, v29, v31, v15 bitop3:0x7e
    ds_write2_b32 v9, v28, v30 offset0:128 offset1:129
    s_waitcnt vmcnt(3)
    v_bitop3_b32 v52, v33, v35, v15 bitop3:0x7e
    ds_write2_b32 v10, v32, v34 offset0:0 offset1:1
    s_waitcnt vmcnt(2)
    v_bitop3_b32 v53, v37, v39, v15 bitop3:0x7e
    ds_write2_b32 v10, v36, v38 offset0:128 offset1:129
    s_waitcnt vmcnt(1)
    v_bitop3_b32 v54, v41, v43, v15 bitop3:0x7e
    ds_write2_b32 v11, v40, v42 offset0:0 offset1:1
    s_waitcnt vmcnt(0)
    v_bitop3_b32 v55, v45, v47, v15 bitop3:0x7e
    ds_write2_b32 v11, v44, v46 offset0:128 offset1:129
    v_or3_b32 v56, v48, v49, v50
    v_or3_b32 v57, v51, v52, v53
    v_or3_b32 v56, v56, v54, v55
    v_or_b32 v56, v56, v57
    v_cmp_ne_u32 vcc, 0, v56
    s_waitcnt lgkmcnt(0)
    s_cbranch_vccnz L_rt_35
L_ok_36:
    s_barrier
    buffer_load_dwordx4 v96, s[20:23], s59 offen nt lds
    s_add_u32 m0, m0, 1024
    s_add_u32 s59, s59, 32768
    buffer_load_dwordx4 v96, s[20:23], s59 offen nt lds
    s_add_u32 m0, m0, 1024
    s_add_u32 s59, s59, 32768
    buffer_load_dwordx4 v96, s[20:23], s59 offen nt lds
    s_add_u32 m0, m0, 1024
    s_add_u32 s59, s59, 32768
    buffer_load_dwordx4 v96, s[20:23], s59 offen nt lds
    s_add_u32 m0, m0, 30208
    s_add_u32 s59, s59, 425984
    buffer_load_dwordx4 v96, s[20:23], s59 offen nt lds
    s_add_u32 m0, m0, 1024
    s_add_u32 s59, s59, 32768
    buffer_load_dwordx4 v96, s[20:23], s59 offen nt lds
    s_add_u32 m0, m0, 1024
    s_add_u32 s59, s59, 32768
    buffer_load_dwordx4 v96, s[20:23], s59 offen nt lds
    s_add_u32 m0, m0, 1024
    s_add_u32 s59, s59, 32768
    buffer_load_dwordx4 v96, s[20:23], s59 offen nt lds
    ds_read_b64_tr_b16 v[130:131], v5 offset:16640
    ds_read_b64_tr_b16 v[146:147], v5 offset:16672
    ds_read_b64_tr_b16 v[162:163], v5 offset:16704
    ds_read_b64_tr_b16 v[178:179], v5 offset:16736
    ds_read_b64_tr_b16 v[194:195], v5 offset:16768
    ds_read_b64_tr_b16 v[210:211], v5 offset:16800
    ds_read_b64_tr_b16 v[226:227], v5 offset:16832
    ds_read_b64_tr_b16 v[242:243], v5 offset:16864
    ds_read_b64_tr_b16 v[134:135], v5 offset:49920
    ds_read_b64_tr_b16 v[150:151], v5 offset:49952
    ds_read_b64_tr_b16 v[166:167], v5 offset:49984
    ds_read_b64_tr_b16 v[182:183], v5 offset:50016
    ds_read_b64_tr_b16 v[198:199], v5 offset:50048
    ds_read_b64_tr_b16 v[214:215], v5 offset:50080
    ds_read_b64_tr_b16 v[230:231], v5 offset:50112
    ds_read_b64_tr_b16 v[246:247], v5 offset:50144
    ds_read_b64_tr_b16 v[138:139], v6 offset:16640
    ds_read_b64_tr_b16 v[154:155], v6 offset:16672
    ds_read_b64_tr_b16 v[170:171], v6 offset:16704
    ds_read_b64_tr_b16 v[186:187], v6 offset:16736
    ds_read_b64_tr_b16 v[202:203], v6 offset:16768
    ds_read_b64_tr_b16 v[218:219], v6 offset:16800
    ds_read_b64_tr_b16 v[234:235], v6 offset:16832
    ds_read_b64_tr_b16 v[250:251], v6 offset:16864
    ds_read_b64_tr_b16 v[142:143], v6 offset:49920
    ds_read_b64_tr_b16 v[158:159], v6 offset:49952
    ds_read_b64_tr_b16 v[174:175], v6 offset:49984
    ds_read_b64_tr_b16 v[190:191], v6 offset:50016
    ds_read_b64_tr_b16 v[206:207], v6 offset:50048
    ds_read_b64_tr_b16 v[222:223], v6 offset:50080
    ds_read_b64_tr_b16 v[238:239], v6 offset:50112
    ds_read_b64_tr_b16 v[254:255], v6 offset:50144
    s_barrier
    s_waitcnt lgkmcnt(0)
    s_barrier
    ds_read_b128 v[48:51], v13 offset:0
    ds_read_b128 v[52:55], v13 offset:1024
    ds_read_b128 v[56:59], v13 offset:2048
    ds_read_b128 v[60:63], v13 offset:3072
    s_waitcnt lgkmcnt(3)
    v_mfma_f32_16x16x32_bf16 v[64:67], v[48:51], v[128:131], 0
    v_mfma_f32_16x16x32_bf16 v[68:71], v[48:51], v[144:147], 0
    s_waitcnt lgkmcnt(2)
    v_mfma_f32_16x16x32_bf16 v[64:67], v[52:55], v[132:135], v[64:67]
    v_mfma_f32_16x16x32_bf16 v[68:71], v[52:55], v[148:151], v[68:71]
    s_waitcnt lgkmcnt(1)
    v_mfma_f32_16x16x32_bf16 v[64:67], v[56:59], v[136:139], v[64:67]
    v_mfma_f32_16x16x32_bf16 v[68:71], v[56:59], v[152:155], v[68:71]
    s_waitcnt lgkmcnt(0)
    v_mfma_f32_16x16x32_bf16 v[64:67], v[60:63], v[140:143], v[64:67]
    v_mfma_f32_16x16x32_bf16 v[68:71], v[60:63], v[156:159], v[68:71]
    v_mfma_f32_16x16x32_bf16 v[72:75], v[48:51], v[160:163], 0
    v_mfma_f32_16x16x32_bf16 v[76:79], v[48:51], v[176:179], 0
    v_mfma_f32_16x16x32_bf16 v[72:75], v[52:55], v[164:167], v[72:75]
    v_mfma_f32_16x16x32_bf16 v[76:79], v[52:55], v[180:183], v[76:79]
    v_mfma_f32_16x16x32_bf16 v[72:75], v[56:59], v[168:171], v[72:75]
    v_mfma_f32_16x16x32_bf16 v[76:79], v[56:59], v[184:187], v[76:79]
    v_mfma_f32_16x16x32_bf16 v[72:75], v[60:63], v[172:175], v[72:75]
    v_mfma_f32_16x16x32_bf16 v[76:79], v[60:63], v[188:191], v[76:79]
    v_perm_b32 v16, v68, v64, v3
    v_and_or_b32 v16, v16, v14, s60
    v_mfma_f32_16x16x32_bf16 v[80:83], v[48:51], v[192:195], 0
    v_perm_b32 v20, v69, v65, v3
    v_and_or_b32 v20, v20, v14, s60
    v_mfma_f32_16x16x32_bf16 v[84:87], v[48:51], v[208:211], 0
    v_perm_b32 v24, v70, v66, v3
    v_and_or_b32 v24, v24, v14, s60
    v_mfma_f32_16x16x32_bf16 v[80:83], v[52:55], v[196:199], v[80:83]
    v_perm_b32 v28, v71, v67, v3
    v_and_or_b32 v28, v28, v14, s60
    v_mfma_f32_16x16x32_bf16 v[84:87], v[52:55], v[212:215], v[84:87]
    v_mfma_f32_16x16x32_bf16 v[80:83], v[56:59], v[200:203], v[80:83]
    v_perm_b32 v17, v76, v72, v3
    v_and_or_b32 v17, v17, v14, s61
    v_mfma_f32_16x16x32_bf16 v[84:87], v[56:59], v[216:219], v[84:87]
    v_perm_b32 v21, v77, v73, v3
    v_and_or_b32 v21, v21, v14, s61
    v_mfma_f32_16x16x32_bf16 v[80:83], v[60:63], v[204:207], v[80:83]
    v_perm_b32 v25, v78, v74, v3
    v_and_or_b32 v25, v25, v14, s61
    v_mfma_f32_16x16x32_bf16 v[84:87], v[60:63], v[220:223], v[84:87]
    v_perm_b32 v29, v79, v75, v3
    v_and_or_b32 v29, v29, v14, s61
    v_mfma_f32_16x16x32_bf16 v[88:91], v[48:51], v[224:227], 0
    v_mfma_f32_16x16x32_bf16 v[92:95], v[48:51], v[240:243], 0
    v_mfma_f32_16x16x32_bf16 v[88:91], v[52:55], v[228:231], v[88:91]
    v_mfma_f32_16x16x32_bf16 v[92:95], v[52:55], v[244:247], v[92:95]
    v_mfma_f32_16x16x32_bf16 v[88:91], v[56:59], v[232:235], v[88:91]
    v_mfma_f32_16x16x32_bf16 v[92:95], v[56:59], v[248:251], v[92:95]
    v_mfma_f32_16x16x32_bf16 v[88:91], v[60:63], v[236:239], v[88:91]
    v_mfma_f32_16x16x32_bf16 v[92:95], v[60:63], v[252:255], v[92:95]
    v_perm_b32 v18, v84, v80, v3
    v_and_or_b32 v18, v18, v14, s62
    v_perm_b32 v22, v85, v81, v3
    v_and_or_b32 v22, v22, v14, s62
    v_perm_b32 v26, v86, v82, v3
    v_and_or_b32 v26, v26, v14, s62
    v_perm_b32 v30, v87, v83, v3
    v_and_or_b32 v30, v30, v14, s62
    v_perm_b32 v19, v92, v88, v3
    v_and_or_b32 v19, v19, v14, s63
    buffer_store_dwordx4 v[16:19], v4, s[40:43], s50 offen sc1
    v_perm_b32 v23, v93, v89, v3
    v_and_or_b32 v23, v23, v14, s63
    buffer_store_dwordx4 v[20:23], v4, s[40:43], s51 offen sc1
    v_perm_b32 v27, v94, v90, v3
    v_and_or_b32 v27, v27, v14, s63
    buffer_store_dwordx4 v[24:27], v4, s[40:43], s52 offen sc1
    v_perm_b32 v31, v95, v91, v3
    v_and_or_b32 v31, v31, v14, s63
    buffer_store_dwordx4 v[28:31], v4, s[40:43], s53 offen sc1
    s_waitcnt vmcnt(4)
    s_barrier
    s_lshl_b32 s50, s54, 4
    s_add_u32 s50, s50, s47
    s_cmp_ge_u32 s50, 4
    s_cbranch_scc1 L_end
    s_barrier
    s_mov_b32 s58, 65536
    v_and_b32 v4, 1, v0
    v_lshlrev_b32 v4, 8, v4
    s_and_b32 s59, s2, 63
    s_mul_i32 s59, s59, 640
    s_add_u32 s59, s59, 360448
    buffer_load_dword v48, v4, s[40:43], s59 offen offset:8 sc1
L_chk_37:
    s_waitcnt vmcnt(0)
    v_cmp_ne_u32 vcc, s44, v48
    s_cbranch_vccnz L_rt_38
L_ok_39:
    s_min_u32 s50, s46, 4
    s_lshl_b32 s51, s46, 2
    s_add_u32 s50, s50, s51
    s_lshl_b32 s50, s50, 5
    s_lshl_b32 s52, s47, 3
    s_add_u32 s52, s52, s50
    s_add_u32 s53, s52, 200704
    s_add_u32 s54, s51, s47
    s_lshl_b32 s54, s54, 6
    s_add_u32 s54, s54, 212992
    s_cmp_lt_u32 s46, 4
    s_cselect_b32 s55, 2, 0
    s_cselect_b32 s59, 2, 1
    v_lshrrev_b32 v4, 2, v1
    v_and_b32 v5, 3, v1
    v_lshl_add_u32 v6, v4, 2, v2
    v_mul_u32_u24 v7, 1152, v6
    v_lshl_add_u32 v7, v5, 1, v7
    v_mov_b32 v8, 2146435072
    v_cmp_gt_u32 vcc, s55, v4
    v_lshlrev_b32 v9, 11, v6
    v_lshl_add_u32 v9, v5, 4, v9
    v_cndmask_b32 v3, v8, v7, vcc
    v_cmp_gt_u32 vcc, 2, v4
    v_add_u32 v88, 131072, v9
    v_mov_b32 v15, s44
    v_cndmask_b32 v7, v8, v7, vcc
    v_cndmask_b32 v88, v8, v88, vcc
    v_cndmask_b32 v89, 0, v15, vcc
    v_lshlrev_b32 v10, 7, v2
    v_lshl_add_u32 v10, v5, 1, v10
    v_cmp_eq_u32 vcc, 0, v4
    v_and_b32 v12, 1, v1
    v_lshlrev_b32 v12, 4, v12
    v_cndmask_b32 v10, v8, v10, vcc
    v_cmp_gt_u32 vcc, s59, v2
    v_mov_b32 v13, 0x3f80
    v_lshlrev_b32 v13, v12, v13
    v_cndmask_b32 v10, v8, v10, vcc
    v_cmp_eq_u32 vcc, 0, v2
    v_lshrrev_b32 v12, 1, v1
    v_mov_b32 v79, 0
    v_cndmask_b32 v11, v8, v10, vcc
    v_cmp_eq_u32 vcc, 0, v12
    s_nop 1
    v_cndmask_b32 v76, 0, v13, vcc
    v_cmp_eq_u32 vcc, 1, v12
    s_nop 1
    v_cndmask_b32 v77, 0, v13, vcc
    v_cmp_eq_u32 vcc, 2, v12
    s_nop 1
    v_cndmask_b32 v78, 0, v13, vcc
    v_add_u32 v85, 32768, v9
    v_add_u32 v86, 65536, v9
    v_add_u32 v87, 98304, v9
    v_mov_b32 v14, 0xffff
    s_mov_b32 s58, 65536
    buffer_load_ushort v48, v7, s[40:43], s53 offen offset:0 sc1
    buffer_load_ushort v49, v7, s[40:43], s53 offen offset:32 sc1
    buffer_load_ushort v50, v7, s[40:43], s53 offen offset:64 sc1
    buffer_load_ushort v51, v7, s[40:43], s53 offen offset:96 sc1
    buffer_load_ushort v52, v3, s[40:43], s53 offen offset:128 sc1
L_chk_40:
    s_waitcnt vmcnt(0)
    v_max3_u32 v12, v48, v49, v50
    v_max3_u32 v12, v12, v51, v52
    v_cmp_eq_u32 vcc, v14, v12
    s_cbranch_vccnz L_rt_41
L_ok_42:
    v_lshl_or_b32 v72, v49, 16, v48
    v_lshl_or_b32 v73, v51, 16, v50
    v_mov_b32 v74, v52
    v_mov_b32 v75, 0
    s_mov_b32 s58, 65536
    buffer_load_dwordx4 v[48:51], v9, s[40:43], s54 offen sc1
    buffer_load_dwordx4 v[52:55], v85, s[40:43], s54 offen sc1
    buffer_load_dwordx4 v[56:59], v86, s[40:43], s54 offen sc1
    buffer_load_dwordx4 v[60:63], v87, s[40:43], s54 offen sc1
    buffer_load_dwordx4 v[64:67], v88, s[40:43], s54 offen sc1
L_chk_43:
    v_mfma_f32_16x16x32_bf16 v[80:83], v[76:79], v[72:75], 0
    s_waitcnt vmcnt(4)
    v_mfma_f32_16x16x32_bf16 v[80:83], v[76:79], v[48:51], v[80:83]
    v_xor_b32 v12, v15, v51
    s_waitcnt vmcnt(3)
    v_mfma_f32_16x16x32_bf16 v[80:83], v[76:79], v[52:55], v[80:83]
    v_bitop3_b32 v12, v12, v55, v15 bitop3:0xf6
    s_waitcnt vmcnt(2)
    v_mfma_f32_16x16x32_bf16 v[80:83], v[76:79], v[56:59], v[80:83]
    v_bitop3_b32 v12, v12, v59, v15 bitop3:0xf6
    s_waitcnt vmcnt(1)
    v_mfma_f32_16x16x32_bf16 v[80:83], v[76:79], v[60:63], v[80:83]
    v_bitop3_b32 v12, v12, v63, v15 bitop3:0xf6
    s_waitcnt vmcnt(0)
    v_mfma_f32_16x16x32_bf16 v[80:83], v[76:79], v[64:67], v[80:83]
    v_bitop3_b32 v12, v12, v67, v89 bitop3:0xf6
    v_cmp_ne_u32 vcc, 0, v12
    s_cbranch_vccnz L_rt_44
L_ok_45:
    s_nop 4
    v_add_f32_dpp v80, v80, v80 row_ror:4 row_mask:0xf bank_mask:0xf
    v_add_f32_dpp v81, v81, v81 row_ror:4 row_mask:0xf bank_mask:0xf
    v_add_f32_dpp v82, v82, v82 row_ror:4 row_mask:0xf bank_mask:0xf
    v_add_f32_dpp v83, v83, v83 row_ror:4 row_mask:0xf bank_mask:0xf
    v_add_f32_dpp v80, v80, v80 row_ror:8 row_mask:0xf bank_mask:0xf
    v_add_f32_dpp v81, v81, v81 row_ror:8 row_mask:0xf bank_mask:0xf
    v_add_f32_dpp v82, v82, v82 row_ror:8 row_mask:0xf bank_mask:0xf
    v_add_f32_dpp v83, v83, v83 row_ror:8 row_mask:0xf bank_mask:0xf
    v_cvt_pk_bf16_f32 v12, v80, v81
    v_cvt_pk_bf16_f32 v13, v82, v83
    buffer_store_short v12, v10, s[36:39], s52 offen
    buffer_store_short_d16_hi v12, v11, s[36:39], s52 offen offset:32
    buffer_store_short v13, v11, s[36:39], s52 offen offset:64
    buffer_store_short_d16_hi v13, v11, s[36:39], s52 offen offset:96
    s_cmp_lg_u32 s56, 0
    s_cbranch_scc1 L_end
    v_cmp_eq_u32 vcc, 0, v0
    v_mov_b32 v4, 0
    s_nop 0
    v_cndmask_b32 v4, v8, v4, vcc
    buffer_store_dword v15, v4, s[40:43], 0 offen
    s_endpgm
L_rt_35:
    s_cmp_eq_u32 s58, 0
    s_cbranch_scc1 L_ok_36
    s_sub_u32 s58, s58, 1
    v_cmp_ne_u32 vcc, 0, v48
    s_cbranch_vccz L_sk_46
    s_mov_b64 exec, vcc
    buffer_load_dwordx4 v[16:19], v7, s[40:43], s55 offen offset:0 sc1
    s_mov_b64 exec, -1
L_sk_46:
    v_cmp_ne_u32 vcc, 0, v49
    s_cbranch_vccz L_sk_47
    s_mov_b64 exec, vcc
    buffer_load_dwordx4 v[20:23], v7, s[40:43], s55 offen offset:1024 sc1
    s_mov_b64 exec, -1
L_sk_47:
    v_cmp_ne_u32 vcc, 0, v50
    s_cbranch_vccz L_sk_48
    s_mov_b64 exec, vcc
    buffer_load_dwordx4 v[24:27], v7, s[40:43], s55 offen offset:2048 sc1
    s_mov_b64 exec, -1
L_sk_48:
    v_cmp_ne_u32 vcc, 0, v51
    s_cbranch_vccz L_sk_49
    s_mov_b64 exec, vcc
    buffer_load_dwordx4 v[28:31], v7, s[40:43], s55 offen offset:3072 sc1
    s_mov_b64 exec, -1
L_sk_49:
    v_cmp_ne_u32 vcc, 0, v52
    s_cbranch_vccz L_sk_50
    s_mov_b64 exec, vcc
    buffer_load_dwordx4 v[32:35], v12, s[40:43], s55 offen offset:0 sc1
    s_mov_b64 exec, -1
L_sk_50:
    v_cmp_ne_u32 vcc, 0, v53
    s_cbranch_vccz L_sk_51
    s_mov_b64 exec, vcc
    buffer_load_dwordx4 v[36:39], v12, s[40:43], s55 offen offset:1024 sc1
    s_mov_b64 exec, -1
L_sk_51:
    v_cmp_ne_u32 vcc, 0, v54
    s_cbranch_vccz L_sk_52
    s_mov_b64 exec, vcc
    buffer_load_dwordx4 v[40:43], v12, s[40:43], s55 offen offset:2048 sc1
    s_mov_b64 exec, -1
L_sk_52:
    v_cmp_ne_u32 vcc, 0, v55
    s_cbranch_vccz L_sk_53
    s_mov_b64 exec, vcc
    buffer_load_dwordx4 v[44:47], v12, s[40:43], s55 offen offset:3072 sc1
    s_mov_b64 exec, -1
L_sk_53:
    s_waitcnt vmcnt(0)
    s_branch L_chk_34
L_rt_38:
    s_cmp_eq_u32 s58, 0
    s_cbranch_scc1 L_ok_39
    s_sub_u32 s58, s58, 1
    s_sleep 4
    buffer_load_dword v48, v4, s[40:43], s59 offen offset:8 sc1
    s_branch L_chk_37
L_rt_41:
    s_cmp_eq_u32 s58, 0
    s_cbranch_scc1 L_ok_42
    s_sub_u32 s58, s58, 1
    s_sleep 2
    buffer_load_ushort v48, v7, s[40:43], s53 offen offset:0 sc1
    buffer_load_ushort v49, v7, s[40:43], s53 offen offset:32 sc1
    buffer_load_ushort v50, v7, s[40:43], s53 offen offset:64 sc1
    buffer_load_ushort v51, v7, s[40:43], s53 offen offset:96 sc1
    buffer_load_ushort v52, v3, s[40:43], s53 offen offset:128 sc1
    s_branch L_chk_40
L_rt_44:
    s_cmp_eq_u32 s58, 0
    s_cbranch_scc1 L_ok_45
    s_sub_u32 s58, s58, 1
    buffer_load_dwordx4 v[48:51], v9, s[40:43], s54 offen sc1
    buffer_load_dwordx4 v[52:55], v85, s[40:43], s54 offen sc1
    buffer_load_dwordx4 v[56:59], v86, s[40:43], s54 offen sc1
    buffer_load_dwordx4 v[60:63], v87, s[40:43], s54 offen sc1
    buffer_load_dwordx4 v[64:67], v88, s[40:43], s54 offen sc1
    s_branch L_chk_43
L_exit:
    s_endpgm
L_codeend:
.section .rodata,"a"
.p2align 6
.amdhsa_kernel sequential_preLN__compressed_kv_cla__dense_activation_silu__decode_kernel
  .amdhsa_next_free_vgpr 256
  .amdhsa_next_free_sgpr 64
  .amdhsa_accum_offset 256
  .amdhsa_group_segment_fixed_size 0
  .amdhsa_kernarg_size 96
  .amdhsa_user_sgpr_count 2
  .amdhsa_user_sgpr_kernarg_segment_ptr 1
  .amdhsa_system_sgpr_workgroup_id_x 1
.end_amdhsa_kernel
```
